```python
import torch

def _softmax(x, axis=-1):
    return torch.softmax(x, dim=axis)

def _gelu(x):
    return torch.nn.functional.gelu(x, approximate='tanh')

def _silu(x):
    return torch.nn.functional.silu(x)

def _sigmoid(x):
    return torch.sigmoid(x)

def _layernorm(x, axis=-1, eps=1e-05):
    m = x.mean(dim=axis, keepdim=True)
    v = x.var(dim=axis, keepdim=True, unbiased=False)
    return (x - m) / torch.sqrt(v + eps)

def _scatter_add(tgt, idx, src, axis=0):
    return tgt.clone().index_add_(axis, idx, src)

def _segment_sum(src, seg, n):
    out = torch.zeros((n,) + src.shape[1:], dtype=src.dtype)
    return out.index_add_(0, seg, src)

def _pad(x, pw):
    flat = tuple((v for pair in reversed(pw) for v in pair))
    return torch.nn.functional.pad(x, flat)
kernel_name = 'standalone__tree_speculative_verify_tree_attention_over_candidate_token_tree__sampling'

def setup_inputs():

    _w = lambda a: (lambda t: t.to(torch.bfloat16) if t.is_floating_point() else t)(torch.as_tensor(a))
    B, Hq, Hkv, T, C, D = (8, 16, 8, 32, 2048, 256)
    tree_mask = torch.zeros((B, T, T), dtype=float)
    for b in range(B):
        parent = torch.zeros(T, dtype=torch.int64)
        for i in range(1, T):
            parent[i] = int(torch.randint(0, i, (1,)).item())
        for i in range(T):
            j = i
            tree_mask[b, i, j] = 1.0
            while j > 0:
                j = parent[j]
                tree_mask[b, i, j] = 1.0
    return {'q': _w((lambda *s: torch.randn(*s, dtype=torch.bfloat16) * 0.8)(B, Hq, T, D)), 'k_cache': _w((lambda *s: torch.randn(*s, dtype=torch.bfloat16) * 0.8)(B, Hkv, C, D)), 'v_cache': _w((lambda *s: torch.randn(*s, dtype=torch.bfloat16) * 0.05)(B, Hkv, C, D)), 'k_tree': _w((lambda *s: torch.randn(*s, dtype=torch.bfloat16) * 0.8)(B, Hkv, T, D)), 'v_tree': _w((lambda *s: torch.randn(*s, dtype=torch.bfloat16) * 0.05)(B, Hkv, T, D)), 'tree_mask': _w(tree_mask)}

def reference(q, k_cache, v_cache, k_tree, v_tree, tree_mask):
    B, Hq, T, D = q.shape
    Hkv, C = (k_cache.shape[1], k_cache.shape[2])
    rep = Hq // Hkv
    kc = (lambda x, n, axis: torch.repeat_interleave(x, n, dim=axis))(k_cache, rep, axis=1)
    vc = (lambda x, n, axis: torch.repeat_interleave(x, n, dim=axis))(v_cache, rep, axis=1)
    kt = (lambda x, n, axis: torch.repeat_interleave(x, n, dim=axis))(k_tree, rep, axis=1)
    vt = (lambda x, n, axis: torch.repeat_interleave(x, n, dim=axis))(v_tree, rep, axis=1)
    k = torch.concatenate([kc, kt], axis=2)
    v = torch.concatenate([vc, vt], axis=2)
    scale = D ** (-0.5)
    scores = torch.einsum('bhqd,bhkd->bhqk', q, k) * scale
    ctx_mask = torch.ones((B, 1, T, C), dtype=scores.dtype)
    tm = tree_mask[:, None, :, :].clone()
    full_mask = torch.concatenate([ctx_mask, tm], axis=-1)
    scores = scores + (1.0 - full_mask) * -1000000000.0
    p = _softmax(scores, axis=-1)
    return torch.einsum('bhqk,bhkd->bhqd', p, v)
```

```asm
; @launch grid=(256,1,1) block=(512,1,1) lds=139328
.amdgcn_target "amdgcn-amd-amdhsa--gfx950"
.text
.globl standalone__tree_speculative_verify_tree_attention_over_candidate_token_tree__sampling_kernel
.p2align 8
.type standalone__tree_speculative_verify_tree_attention_over_candidate_token_tree__sampling_kernel,@function
standalone__tree_speculative_verify_tree_attention_over_candidate_token_tree__sampling_kernel:
    s_cmp_ge_u32 s2, 256
    s_cbranch_scc1 L_end
    s_load_dwordx16 s[4:19], s[0:1], 0
    s_load_dwordx2 s[20:21], s[0:1], 64
    v_lshrrev_b32 v1, 6, v0
    v_and_b32 v0, 63, v0
    v_readfirstlane_b32 s60, v1
    s_and_b32 s63, s2, 7
    s_lshr_b32 s62, s2, 5
    s_lshl_b32 s62, s62, 3
    s_add_u32 s63, s63, s62
    s_lshr_b32 s62, s2, 3
    s_and_b32 s62, s62, 3
    s_lshl_b32 s3, s63, 2
    s_add_u32 s3, s3, s62
    s_and_b32 s61, s60, 3
    v_lshrrev_b32 v4, 3, v0
    v_lshlrev_b32 v4, 9, v4
    v_lshrrev_b32 v5, 4, v0
    v_and_b32 v6, 7, v0
    v_xor_b32 v7, v6, v5
    v_lshl_add_u32 v1, v7, 4, v4
    v_xor_b32 v7, 4, v7
    v_lshl_add_u32 v2, v7, 4, v4
    v_and_b32 v7, 1, v5
    v_lshlrev_b32 v7, 2, v7
    v_xor_b32 v7, v6, v7
    v_lshl_add_u32 v3, v7, 4, v4
    v_lshlrev_b32 v17, 4, v0
    s_lshl_b32 s22, s3, 18
    s_lshl_b32 s23, s61, 16
    s_add_u32 s22, s22, s23
    s_lshl_b32 s70, s63, 15
    s_lshl_b32 s71, s63, 14
    s_lshl_b32 s72, s62, 12
    s_add_u32 s71, s71, s72
    s_lshr_b32 s73, s63, 3
    s_lshl_b32 s73, s73, 11
    s_mul_i32 s64, s61, 16384
    s_add_u32 s66, s62, 1
    s_and_b32 s66, s66, 3
    s_lshl_b32 s66, s66, 7
    s_add_u32 s67, s62, 2
    s_and_b32 s67, s67, 3
    s_lshl_b32 s67, s67, 7
    s_add_u32 s68, s62, 3
    s_and_b32 s68, s68, 3
    s_lshl_b32 s68, s68, 7
    s_add_u32 s69, s62, 4
    s_and_b32 s69, s69, 3
    s_lshl_b32 s69, s69, 7
    s_mov_b32 s77, 0x3db8aa3b
    s_waitcnt lgkmcnt(0)
    s_add_u32 s36, s4, s70
    s_addc_u32 s37, s5, 0
    s_and_b32 s37, s37, 0xffff
    s_mov_b32 s38, 32768
    s_mov_b32 s39, 0x20000
    s_add_u32 s40, s10, s71
    s_addc_u32 s41, s11, 0
    s_and_b32 s41, s41, 0xffff
    s_mov_b32 s42, 4096
    s_mov_b32 s43, 0x20000
    s_add_u32 s44, s12, s71
    s_addc_u32 s45, s13, 0
    s_and_b32 s45, s45, 0xffff
    s_mov_b32 s46, 4096
    s_mov_b32 s47, 0x20000
    s_add_u32 s24, s6, s22
    s_addc_u32 s25, s7, 0
    s_and_b32 s25, s25, 0xffff
    s_mov_b32 s26, 65536
    s_mov_b32 s27, 0x20000
    s_add_u32 s28, s8, s22
    s_addc_u32 s29, s9, 0
    s_and_b32 s29, s29, 0xffff
    s_mov_b32 s30, 65536
    s_mov_b32 s31, 0x20000
    s_add_u32 s32, s14, s73
    s_addc_u32 s33, s15, 0
    s_and_b32 s33, s33, 0xffff
    s_mov_b32 s34, 2048
    s_mov_b32 s35, 0x20000
    s_add_u32 s48, s16, s70
    s_addc_u32 s49, s17, 0
    s_and_b32 s49, s49, 0xffff
    s_mov_b32 s50, 32768
    s_mov_b32 s51, 0x20000
    s_mov_b32 s52, s18
    s_and_b32 s53, s19, 0xffff
    s_mov_b32 s54, 256
    s_mov_b32 s55, 0x20000
    s_mov_b32 s56, s20
    s_and_b32 s57, s21, 0xffff
    s_mov_b32 s58, 268435456
    s_mov_b32 s59, 0x20000
    s_cmp_ge_u32 s60, 4
    s_cbranch_scc0 L_stream
    s_barrier
    s_branch L_helper
L_stream:
    s_add_u32 s4, s61, s62
    s_add_u32 s4, s4, 0
    s_and_b32 s4, s4, 3
    s_lshl_b32 s4, s4, 7
    s_add_u32 s5, s61, s62
    s_add_u32 s5, s5, 1
    s_and_b32 s5, s5, 3
    s_lshl_b32 s5, s5, 7
    s_add_u32 s6, s61, s62
    s_add_u32 s6, s6, 2
    s_and_b32 s6, s6, 3
    s_lshl_b32 s6, s6, 7
    s_add_u32 s7, s61, s62
    s_add_u32 s7, s7, 3
    s_and_b32 s7, s7, 3
    s_lshl_b32 s7, s7, 7
    s_lshl_b32 s74, s4, 5
    s_add_u32 m0, s74, 65536
    s_add_u32 s65, s4, 0
    buffer_load_dwordx4 v1, s[36:39], s65 offen nt lds
    s_add_u32 m0, s74, 66560
    s_add_u32 s65, s4, 4096
    buffer_load_dwordx4 v2, s[36:39], s65 offen nt lds
    s_add_u32 m0, s74, 67584
    s_add_u32 s65, s4, 8192
    buffer_load_dwordx4 v1, s[36:39], s65 offen nt lds
    s_add_u32 m0, s74, 68608
    s_add_u32 s65, s4, 12288
    buffer_load_dwordx4 v2, s[36:39], s65 offen nt lds
    s_add_u32 m0, s74, 81920
    s_add_u32 s65, s4, 16384
    buffer_load_dwordx4 v1, s[36:39], s65 offen nt lds
    s_add_u32 m0, s74, 82944
    s_add_u32 s65, s4, 20480
    buffer_load_dwordx4 v2, s[36:39], s65 offen nt lds
    s_add_u32 m0, s74, 83968
    s_add_u32 s65, s4, 24576
    buffer_load_dwordx4 v1, s[36:39], s65 offen nt lds
    s_add_u32 m0, s74, 84992
    s_add_u32 s65, s4, 28672
    buffer_load_dwordx4 v2, s[36:39], s65 offen nt lds
    s_lshl_b32 s74, s61, 10
    s_add_u32 m0, s74, 98304
    v_and_b32 v24, 31, v0
    buffer_load_dwordx4 v17, s[40:43], s74 offen nt lds
    s_add_u32 m0, s74, 131072
    v_lshlrev_b32 v25, 6, v24
    buffer_load_dwordx4 v17, s[44:47], s74 offen nt lds
    s_lshl_b32 s74, s62, 4
    s_lshl_b32 s75, s61, 2
    s_add_u32 s74, s74, s75
    buffer_load_dword v19, v25, s[32:35], s74 offen
    s_add_u32 m0, s64, 0
    s_add_u32 s65, s4, 0
    buffer_load_dwordx4 v1, s[24:27], s65 offen nt lds
    s_add_u32 m0, s64, 1024
    s_add_u32 s65, s4, 4096
    buffer_load_dwordx4 v2, s[24:27], s65 offen nt lds
    s_add_u32 m0, s64, 2048
    s_add_u32 s65, s4, 8192
    buffer_load_dwordx4 v1, s[24:27], s65 offen nt lds
    s_add_u32 m0, s64, 3072
    s_add_u32 s65, s4, 12288
    buffer_load_dwordx4 v2, s[24:27], s65 offen nt lds
    s_add_u32 m0, s64, 4096
    s_add_u32 s65, s4, 16384
    buffer_load_dwordx4 v1, s[24:27], s65 offen nt lds
    s_add_u32 m0, s64, 5120
    s_add_u32 s65, s4, 20480
    buffer_load_dwordx4 v2, s[24:27], s65 offen nt lds
    s_add_u32 m0, s64, 6144
    s_add_u32 s65, s4, 24576
    buffer_load_dwordx4 v1, s[24:27], s65 offen nt lds
    s_add_u32 m0, s64, 7168
    s_add_u32 s65, s4, 28672
    buffer_load_dwordx4 v2, s[24:27], s65 offen nt lds
    s_add_u32 m0, s64, 8192
    s_add_u32 s65, s4, 32768
    buffer_load_dwordx4 v1, s[24:27], s65 offen nt lds
    s_add_u32 m0, s64, 9216
    s_add_u32 s65, s4, 36864
    buffer_load_dwordx4 v2, s[24:27], s65 offen nt lds
    s_add_u32 m0, s64, 10240
    s_add_u32 s65, s4, 40960
    buffer_load_dwordx4 v1, s[24:27], s65 offen nt lds
    s_add_u32 m0, s64, 11264
    s_add_u32 s65, s4, 45056
    buffer_load_dwordx4 v2, s[24:27], s65 offen nt lds
    s_add_u32 m0, s64, 12288
    s_add_u32 s65, s4, 49152
    buffer_load_dwordx4 v1, s[24:27], s65 offen nt lds
    s_add_u32 m0, s64, 13312
    s_add_u32 s65, s4, 53248
    buffer_load_dwordx4 v2, s[24:27], s65 offen nt lds
    s_add_u32 m0, s64, 14336
    s_add_u32 s65, s4, 57344
    buffer_load_dwordx4 v1, s[24:27], s65 offen nt lds
    s_add_u32 m0, s64, 15360
    s_add_u32 s65, s4, 61440
    buffer_load_dwordx4 v2, s[24:27], s65 offen nt lds
    v_lshrrev_b32 v25, 5, v0
    v_lshrrev_b32 v26, 1, v24
    v_and_b32 v26, 7, v26
    v_xor_b32 v26, v26, v25
    v_lshlrev_b32 v27, 7, v24
    v_xor_b32 v30, 0, v26
    v_lshl_add_u32 v30, v30, 4, v27
    v_add_u32 v4, s64, v30
    v_add_u32 v8, 65536, v30
    v_xor_b32 v30, 2, v26
    v_lshl_add_u32 v30, v30, 4, v27
    v_add_u32 v5, s64, v30
    v_add_u32 v9, 65536, v30
    v_xor_b32 v30, 4, v26
    v_lshl_add_u32 v30, v30, 4, v27
    v_add_u32 v6, s64, v30
    v_add_u32 v10, 65536, v30
    v_xor_b32 v30, 6, v26
    v_lshl_add_u32 v30, v30, 4, v27
    v_add_u32 v7, s64, v30
    v_add_u32 v11, 65536, v30
    v_and_b32 v30, 1, v24
    v_lshlrev_b32 v30, 9, v30
    v_lshl_add_u32 v30, v25, 4, v30
    s_lshl_b32 s75, s61, 10
    s_add_u32 s76, s75, 98304
    v_add_u32 v14, s76, v30
    v_lshrrev_b32 v30, 2, v0
    v_and_b32 v30, 3, v30
    v_lshl_add_u32 v31, v25, 2, v30
    v_lshlrev_b32 v31, 7, v31
    v_lshrrev_b32 v12, 4, v0
    v_and_b32 v12, 1, v12
    v_lshlrev_b32 v12, 5, v12
    v_and_b32 v13, 3, v0
    v_lshl_add_u32 v12, v13, 3, v12
    v_lshrrev_b32 v13, 1, v30
    v_lshlrev_b32 v13, 6, v13
    v_add_u32 v31, v31, v12
    v_add_u32 v31, s64, v31
    v_and_b32 v15, 1, v30
    v_lshl_add_u32 v15, v15, 9, v12
    s_add_u32 s76, s75, 131072
    v_add_u32 v15, s76, v15
    v_xor_b32 v16, 64, v13
    v_add_u32 v12, v31, v13
    v_add_u32 v13, v31, v16
    s_lshl_b32 s76, s61, 14
    s_add_u32 s76, s76, 65536
    v_add_u32 v17, s76, v17
    s_lshl_b32 s76, s61, 10
    s_add_u32 s76, s76, 135168
    v_lshlrev_b32 v18, 3, v0
    v_add_u32 v18, s76, v18
    v_mov_b32 v16, 139264
    v_lshl_add_u32 v30, v0, 2, v16
    v_mov_b32 v31, 0
    s_mov_b64 exec, 0xffff
    ds_write_b32 v30, v31
    s_mov_b64 exec, -1
    s_waitcnt vmcnt(16) lgkmcnt(0)
    s_lshl_b32 s8, s4, 5
    v_add_u32 v24, s8, v8
    v_add_u32 v25, s8, v9
    v_add_u32 v26, s8, v10
    v_add_u32 v27, s8, v11
    ds_read_b128 a[32:35], v24 offset:0
    ds_read_b128 a[48:51], v24 offset:16384
    ds_read_b128 a[36:39], v25 offset:0
    ds_read_b128 a[52:55], v25 offset:16384
    ds_read_b128 a[40:43], v26 offset:0
    ds_read_b128 a[56:59], v26 offset:16384
    ds_read_b128 a[44:47], v27 offset:0
    ds_read_b128 a[60:63], v27 offset:16384
    v_add_u32 v28, s4, v14
    ds_read_b128 a[0:3], v28 offset:0
    ds_read_b128 a[4:7], v28 offset:32
    ds_read_b128 a[8:11], v28 offset:64
    ds_read_b128 a[12:15], v28 offset:96
    v_lshlrev_b32 v20, 16, v19
    v_and_b32 v21, 0xffff0000, v19
    v_sub_f32 v20, 1.0, v20
    v_sub_f32 v21, 1.0, v21
    v_mul_f32 v20, 0xd06e6b28, v20
    v_mul_f32 v21, 0xd06e6b28, v21
    v_mov_b32 v30, 0xff800000
    v_cmp_gt_u32 vcc, 32, v0
    v_mov_b32 v19, 1
    s_nop 0
    v_cndmask_b32 v20, v30, v20, vcc
    v_cndmask_b32 v21, v30, v21, vcc
    s_waitcnt lgkmcnt(0)
    v_mfma_f32_32x32x16_bf16 a[64:79], a[0:3], a[32:35], 0
    v_mfma_f32_32x32x16_bf16 a[80:95], a[0:3], a[48:51], 0
    v_mfma_f32_32x32x16_bf16 a[64:79], a[4:7], a[36:39], a[64:79]
    v_mfma_f32_32x32x16_bf16 a[80:95], a[4:7], a[52:55], a[80:95]
    s_waitcnt vmcnt(12)
    ds_read_b128 a[16:19], v4 offset:0
    ds_read_b128 a[20:23], v5 offset:0
    ds_read_b128 a[24:27], v6 offset:0
    ds_read_b128 a[28:31], v7 offset:0
    v_mfma_f32_32x32x16_bf16 a[64:79], a[8:11], a[40:43], a[64:79]
    v_mfma_f32_32x32x16_bf16 a[80:95], a[8:11], a[56:59], a[80:95]
    v_mfma_f32_32x32x16_bf16 a[64:79], a[12:15], a[44:47], a[64:79]
    v_mfma_f32_32x32x16_bf16 a[80:95], a[12:15], a[60:63], a[80:95]
    s_waitcnt lgkmcnt(0)
    v_mfma_f32_32x32x16_bf16 v[32:47], a[16:19], a[32:35], 0
    s_add_u32 m0, s64, 0
    s_add_u32 s65, s5, 0
    buffer_load_dwordx4 v1, s[24:27], s65 offen nt lds
    v_mfma_f32_32x32x16_bf16 v[48:63], a[16:19], a[48:51], 0
    s_add_u32 m0, s64, 1024
    s_add_u32 s65, s5, 4096
    buffer_load_dwordx4 v2, s[24:27], s65 offen nt lds
    v_mfma_f32_32x32x16_bf16 v[32:47], a[20:23], a[36:39], v[32:47]
    s_add_u32 m0, s64, 2048
    s_add_u32 s65, s5, 8192
    buffer_load_dwordx4 v1, s[24:27], s65 offen nt lds
    v_mfma_f32_32x32x16_bf16 v[48:63], a[20:23], a[52:55], v[48:63]
    s_add_u32 m0, s64, 3072
    s_add_u32 s65, s5, 12288
    buffer_load_dwordx4 v2, s[24:27], s65 offen nt lds
    s_waitcnt vmcnt(12)
    ds_read_b128 a[0:3], v4 offset:4096
    ds_read_b128 a[4:7], v5 offset:4096
    ds_read_b128 a[8:11], v6 offset:4096
    ds_read_b128 a[12:15], v7 offset:4096
    v_mfma_f32_32x32x16_bf16 v[32:47], a[24:27], a[40:43], v[32:47]
    v_mfma_f32_32x32x16_bf16 v[48:63], a[24:27], a[56:59], v[48:63]
    v_mfma_f32_32x32x16_bf16 v[32:47], a[28:31], a[44:47], v[32:47]
    v_mfma_f32_32x32x16_bf16 v[48:63], a[28:31], a[60:63], v[48:63]
    s_waitcnt lgkmcnt(0)
    v_mfma_f32_32x32x16_bf16 v[64:79], a[0:3], a[32:35], 0
    s_add_u32 m0, s64, 4096
    s_add_u32 s65, s5, 16384
    buffer_load_dwordx4 v1, s[24:27], s65 offen nt lds
    v_mfma_f32_32x32x16_bf16 v[80:95], a[0:3], a[48:51], 0
    s_add_u32 m0, s64, 5120
    s_add_u32 s65, s5, 20480
    buffer_load_dwordx4 v2, s[24:27], s65 offen nt lds
    v_mfma_f32_32x32x16_bf16 v[64:79], a[4:7], a[36:39], v[64:79]
    s_add_u32 m0, s64, 6144
    s_add_u32 s65, s5, 24576
    buffer_load_dwordx4 v1, s[24:27], s65 offen nt lds
    v_mfma_f32_32x32x16_bf16 v[80:95], a[4:7], a[52:55], v[80:95]
    s_add_u32 m0, s64, 7168
    s_add_u32 s65, s5, 28672
    buffer_load_dwordx4 v2, s[24:27], s65 offen nt lds
    s_waitcnt vmcnt(12)
    ds_read_b128 a[16:19], v4 offset:8192
    ds_read_b128 a[20:23], v5 offset:8192
    ds_read_b128 a[24:27], v6 offset:8192
    ds_read_b128 a[28:31], v7 offset:8192
    v_mfma_f32_32x32x16_bf16 v[64:79], a[8:11], a[40:43], v[64:79]
    v_mfma_f32_32x32x16_bf16 v[80:95], a[8:11], a[56:59], v[80:95]
    v_mfma_f32_32x32x16_bf16 v[64:79], a[12:15], a[44:47], v[64:79]
    v_mfma_f32_32x32x16_bf16 v[80:95], a[12:15], a[60:63], v[80:95]
    s_waitcnt lgkmcnt(0)
    v_mfma_f32_32x32x16_bf16 v[96:111], a[16:19], a[32:35], 0
    s_add_u32 m0, s64, 8192
    s_add_u32 s65, s5, 32768
    buffer_load_dwordx4 v1, s[24:27], s65 offen nt lds
    v_mfma_f32_32x32x16_bf16 v[112:127], a[16:19], a[48:51], 0
    s_add_u32 m0, s64, 9216
    s_add_u32 s65, s5, 36864
    buffer_load_dwordx4 v2, s[24:27], s65 offen nt lds
    v_mfma_f32_32x32x16_bf16 v[96:111], a[20:23], a[36:39], v[96:111]
    s_add_u32 m0, s64, 10240
    s_add_u32 s65, s5, 40960
    buffer_load_dwordx4 v1, s[24:27], s65 offen nt lds
    v_mfma_f32_32x32x16_bf16 v[112:127], a[20:23], a[52:55], v[112:127]
    s_add_u32 m0, s64, 11264
    s_add_u32 s65, s5, 45056
    buffer_load_dwordx4 v2, s[24:27], s65 offen nt lds
    s_waitcnt vmcnt(12)
    ds_read_b128 a[0:3], v4 offset:12288
    ds_read_b128 a[4:7], v5 offset:12288
    ds_read_b128 a[8:11], v6 offset:12288
    ds_read_b128 a[12:15], v7 offset:12288
    v_mfma_f32_32x32x16_bf16 v[96:111], a[24:27], a[40:43], v[96:111]
    v_mfma_f32_32x32x16_bf16 v[112:127], a[24:27], a[56:59], v[112:127]
    v_mfma_f32_32x32x16_bf16 v[96:111], a[28:31], a[44:47], v[96:111]
    v_mfma_f32_32x32x16_bf16 v[112:127], a[28:31], a[60:63], v[112:127]
    s_waitcnt lgkmcnt(0)
    v_mfma_f32_32x32x16_bf16 v[128:143], a[0:3], a[32:35], 0
    s_add_u32 m0, s64, 12288
    s_add_u32 s65, s5, 49152
    buffer_load_dwordx4 v1, s[24:27], s65 offen nt lds
    v_mfma_f32_32x32x16_bf16 v[144:159], a[0:3], a[48:51], 0
    s_add_u32 m0, s64, 13312
    s_add_u32 s65, s5, 53248
    buffer_load_dwordx4 v2, s[24:27], s65 offen nt lds
    v_mfma_f32_32x32x16_bf16 v[128:143], a[4:7], a[36:39], v[128:143]
    s_add_u32 m0, s64, 14336
    s_add_u32 s65, s5, 57344
    buffer_load_dwordx4 v1, s[24:27], s65 offen nt lds
    v_mfma_f32_32x32x16_bf16 v[144:159], a[4:7], a[52:55], v[144:159]
    s_add_u32 m0, s64, 15360
    s_add_u32 s65, s5, 61440
    buffer_load_dwordx4 v2, s[24:27], s65 offen nt lds
    v_add_u32 v28, s5, v14
    ds_read_b128 a[16:19], v28 offset:0
    ds_read_b128 a[20:23], v28 offset:32
    ds_read_b128 a[24:27], v28 offset:64
    ds_read_b128 a[28:31], v28 offset:96
    v_mfma_f32_32x32x16_bf16 v[128:143], a[8:11], a[40:43], v[128:143]
    v_mfma_f32_32x32x16_bf16 v[144:159], a[8:11], a[56:59], v[144:159]
    v_mfma_f32_32x32x16_bf16 v[128:143], a[12:15], a[44:47], v[128:143]
    v_mfma_f32_32x32x16_bf16 v[144:159], a[12:15], a[60:63], v[144:159]
    s_barrier
    s_lshl_b32 s8, s5, 5
    v_add_u32 v24, s8, v8
    v_add_u32 v25, s8, v9
    v_add_u32 v26, s8, v10
    v_add_u32 v27, s8, v11
    ds_read_b128 a[32:35], v24 offset:0
    ds_read_b128 a[48:51], v24 offset:16384
    ds_read_b128 a[36:39], v25 offset:0
    ds_read_b128 a[52:55], v25 offset:16384
    ds_read_b128 a[40:43], v26 offset:0
    ds_read_b128 a[56:59], v26 offset:16384
    ds_read_b128 a[44:47], v27 offset:0
    ds_read_b128 a[60:63], v27 offset:16384
    s_waitcnt lgkmcnt(0)
    v_mfma_f32_32x32x16_bf16 a[64:79], a[16:19], a[32:35], a[64:79]
    v_mfma_f32_32x32x16_bf16 a[80:95], a[16:19], a[48:51], a[80:95]
    v_mfma_f32_32x32x16_bf16 a[64:79], a[20:23], a[36:39], a[64:79]
    v_mfma_f32_32x32x16_bf16 a[80:95], a[20:23], a[52:55], a[80:95]
    s_waitcnt vmcnt(12)
    ds_read_b128 a[0:3], v4 offset:0
    ds_read_b128 a[4:7], v5 offset:0
    ds_read_b128 a[8:11], v6 offset:0
    ds_read_b128 a[12:15], v7 offset:0
    v_mfma_f32_32x32x16_bf16 a[64:79], a[24:27], a[40:43], a[64:79]
    v_mfma_f32_32x32x16_bf16 a[80:95], a[24:27], a[56:59], a[80:95]
    v_mfma_f32_32x32x16_bf16 a[64:79], a[28:31], a[44:47], a[64:79]
    v_mfma_f32_32x32x16_bf16 a[80:95], a[28:31], a[60:63], a[80:95]
    s_waitcnt lgkmcnt(0)
    v_mfma_f32_32x32x16_bf16 v[32:47], a[0:3], a[32:35], v[32:47]
    s_add_u32 m0, s64, 0
    s_add_u32 s65, s6, 0
    buffer_load_dwordx4 v1, s[24:27], s65 offen nt lds
    v_mfma_f32_32x32x16_bf16 v[48:63], a[0:3], a[48:51], v[48:63]
    s_add_u32 m0, s64, 1024
    s_add_u32 s65, s6, 4096
    buffer_load_dwordx4 v2, s[24:27], s65 offen nt lds
    v_mfma_f32_32x32x16_bf16 v[32:47], a[4:7], a[36:39], v[32:47]
    s_add_u32 m0, s64, 2048
    s_add_u32 s65, s6, 8192
    buffer_load_dwordx4 v1, s[24:27], s65 offen nt lds
    v_mfma_f32_32x32x16_bf16 v[48:63], a[4:7], a[52:55], v[48:63]
    s_add_u32 m0, s64, 3072
    s_add_u32 s65, s6, 12288
    buffer_load_dwordx4 v2, s[24:27], s65 offen nt lds
    s_waitcnt vmcnt(12)
    ds_read_b128 a[16:19], v4 offset:4096
    ds_read_b128 a[20:23], v5 offset:4096
    ds_read_b128 a[24:27], v6 offset:4096
    ds_read_b128 a[28:31], v7 offset:4096
    v_mfma_f32_32x32x16_bf16 v[32:47], a[8:11], a[40:43], v[32:47]
    v_mfma_f32_32x32x16_bf16 v[48:63], a[8:11], a[56:59], v[48:63]
    v_mfma_f32_32x32x16_bf16 v[32:47], a[12:15], a[44:47], v[32:47]
    v_mfma_f32_32x32x16_bf16 v[48:63], a[12:15], a[60:63], v[48:63]
    s_waitcnt lgkmcnt(0)
    v_mfma_f32_32x32x16_bf16 v[64:79], a[16:19], a[32:35], v[64:79]
    s_add_u32 m0, s64, 4096
    s_add_u32 s65, s6, 16384
    buffer_load_dwordx4 v1, s[24:27], s65 offen nt lds
    v_mfma_f32_32x32x16_bf16 v[80:95], a[16:19], a[48:51], v[80:95]
    s_add_u32 m0, s64, 5120
    s_add_u32 s65, s6, 20480
    buffer_load_dwordx4 v2, s[24:27], s65 offen nt lds
    v_mfma_f32_32x32x16_bf16 v[64:79], a[20:23], a[36:39], v[64:79]
    s_add_u32 m0, s64, 6144
    s_add_u32 s65, s6, 24576
    buffer_load_dwordx4 v1, s[24:27], s65 offen nt lds
    v_mfma_f32_32x32x16_bf16 v[80:95], a[20:23], a[52:55], v[80:95]
    s_add_u32 m0, s64, 7168
    s_add_u32 s65, s6, 28672
    buffer_load_dwordx4 v2, s[24:27], s65 offen nt lds
    s_waitcnt vmcnt(12)
    ds_read_b128 a[0:3], v4 offset:8192
    ds_read_b128 a[4:7], v5 offset:8192
    ds_read_b128 a[8:11], v6 offset:8192
    ds_read_b128 a[12:15], v7 offset:8192
    v_mfma_f32_32x32x16_bf16 v[64:79], a[24:27], a[40:43], v[64:79]
    v_mfma_f32_32x32x16_bf16 v[80:95], a[24:27], a[56:59], v[80:95]
    v_mfma_f32_32x32x16_bf16 v[64:79], a[28:31], a[44:47], v[64:79]
    v_mfma_f32_32x32x16_bf16 v[80:95], a[28:31], a[60:63], v[80:95]
    s_waitcnt lgkmcnt(0)
    v_mfma_f32_32x32x16_bf16 v[96:111], a[0:3], a[32:35], v[96:111]
    s_add_u32 m0, s64, 8192
    s_add_u32 s65, s6, 32768
    buffer_load_dwordx4 v1, s[24:27], s65 offen nt lds
    v_mfma_f32_32x32x16_bf16 v[112:127], a[0:3], a[48:51], v[112:127]
    s_add_u32 m0, s64, 9216
    s_add_u32 s65, s6, 36864
    buffer_load_dwordx4 v2, s[24:27], s65 offen nt lds
    v_mfma_f32_32x32x16_bf16 v[96:111], a[4:7], a[36:39], v[96:111]
    s_add_u32 m0, s64, 10240
    s_add_u32 s65, s6, 40960
    buffer_load_dwordx4 v1, s[24:27], s65 offen nt lds
    v_mfma_f32_32x32x16_bf16 v[112:127], a[4:7], a[52:55], v[112:127]
    s_add_u32 m0, s64, 11264
    s_add_u32 s65, s6, 45056
    buffer_load_dwordx4 v2, s[24:27], s65 offen nt lds
    s_waitcnt vmcnt(12)
    ds_read_b128 a[16:19], v4 offset:12288
    ds_read_b128 a[20:23], v5 offset:12288
    ds_read_b128 a[24:27], v6 offset:12288
    ds_read_b128 a[28:31], v7 offset:12288
    v_mfma_f32_32x32x16_bf16 v[96:111], a[8:11], a[40:43], v[96:111]
    v_mfma_f32_32x32x16_bf16 v[112:127], a[8:11], a[56:59], v[112:127]
    v_mfma_f32_32x32x16_bf16 v[96:111], a[12:15], a[44:47], v[96:111]
    v_mfma_f32_32x32x16_bf16 v[112:127], a[12:15], a[60:63], v[112:127]
    s_waitcnt lgkmcnt(0)
    v_mfma_f32_32x32x16_bf16 v[128:143], a[16:19], a[32:35], v[128:143]
    s_add_u32 m0, s64, 12288
    s_add_u32 s65, s6, 49152
    buffer_load_dwordx4 v1, s[24:27], s65 offen nt lds
    v_mfma_f32_32x32x16_bf16 v[144:159], a[16:19], a[48:51], v[144:159]
    s_add_u32 m0, s64, 13312
    s_add_u32 s65, s6, 53248
    buffer_load_dwordx4 v2, s[24:27], s65 offen nt lds
    v_mfma_f32_32x32x16_bf16 v[128:143], a[20:23], a[36:39], v[128:143]
    s_add_u32 m0, s64, 14336
    s_add_u32 s65, s6, 57344
    buffer_load_dwordx4 v1, s[24:27], s65 offen nt lds
    v_mfma_f32_32x32x16_bf16 v[144:159], a[20:23], a[52:55], v[144:159]
    s_add_u32 m0, s64, 15360
    s_add_u32 s65, s6, 61440
    buffer_load_dwordx4 v2, s[24:27], s65 offen nt lds
    v_add_u32 v28, s6, v14
    ds_read_b128 a[0:3], v28 offset:0
    ds_read_b128 a[4:7], v28 offset:32
    ds_read_b128 a[8:11], v28 offset:64
    ds_read_b128 a[12:15], v28 offset:96
    v_mfma_f32_32x32x16_bf16 v[128:143], a[24:27], a[40:43], v[128:143]
    v_mfma_f32_32x32x16_bf16 v[144:159], a[24:27], a[56:59], v[144:159]
    v_mfma_f32_32x32x16_bf16 v[128:143], a[28:31], a[44:47], v[128:143]
    v_mfma_f32_32x32x16_bf16 v[144:159], a[28:31], a[60:63], v[144:159]
    s_lshl_b32 s8, s6, 5
    v_add_u32 v24, s8, v8
    v_add_u32 v25, s8, v9
    v_add_u32 v26, s8, v10
    v_add_u32 v27, s8, v11
    ds_read_b128 a[32:35], v24 offset:0
    ds_read_b128 a[48:51], v24 offset:16384
    ds_read_b128 a[36:39], v25 offset:0
    ds_read_b128 a[52:55], v25 offset:16384
    ds_read_b128 a[40:43], v26 offset:0
    ds_read_b128 a[56:59], v26 offset:16384
    ds_read_b128 a[44:47], v27 offset:0
    ds_read_b128 a[60:63], v27 offset:16384
    s_waitcnt lgkmcnt(0)
    v_mfma_f32_32x32x16_bf16 a[64:79], a[0:3], a[32:35], a[64:79]
    v_mfma_f32_32x32x16_bf16 a[80:95], a[0:3], a[48:51], a[80:95]
    v_mfma_f32_32x32x16_bf16 a[64:79], a[4:7], a[36:39], a[64:79]
    v_mfma_f32_32x32x16_bf16 a[80:95], a[4:7], a[52:55], a[80:95]
    s_waitcnt vmcnt(12)
    ds_read_b128 a[16:19], v4 offset:0
    ds_read_b128 a[20:23], v5 offset:0
    ds_read_b128 a[24:27], v6 offset:0
    ds_read_b128 a[28:31], v7 offset:0
    v_mfma_f32_32x32x16_bf16 a[64:79], a[8:11], a[40:43], a[64:79]
    v_mfma_f32_32x32x16_bf16 a[80:95], a[8:11], a[56:59], a[80:95]
    v_mfma_f32_32x32x16_bf16 a[64:79], a[12:15], a[44:47], a[64:79]
    v_mfma_f32_32x32x16_bf16 a[80:95], a[12:15], a[60:63], a[80:95]
    s_waitcnt lgkmcnt(0)
    v_mfma_f32_32x32x16_bf16 v[32:47], a[16:19], a[32:35], v[32:47]
    s_add_u32 m0, s64, 0
    s_add_u32 s65, s7, 0
    buffer_load_dwordx4 v1, s[24:27], s65 offen nt lds
    v_mfma_f32_32x32x16_bf16 v[48:63], a[16:19], a[48:51], v[48:63]
    s_add_u32 m0, s64, 1024
    s_add_u32 s65, s7, 4096
    buffer_load_dwordx4 v2, s[24:27], s65 offen nt lds
    v_mfma_f32_32x32x16_bf16 v[32:47], a[20:23], a[36:39], v[32:47]
    s_add_u32 m0, s64, 2048
    s_add_u32 s65, s7, 8192
    buffer_load_dwordx4 v1, s[24:27], s65 offen nt lds
    v_mfma_f32_32x32x16_bf16 v[48:63], a[20:23], a[52:55], v[48:63]
    s_add_u32 m0, s64, 3072
    s_add_u32 s65, s7, 12288
    buffer_load_dwordx4 v2, s[24:27], s65 offen nt lds
    s_waitcnt vmcnt(12)
    ds_read_b128 a[0:3], v4 offset:4096
    ds_read_b128 a[4:7], v5 offset:4096
    ds_read_b128 a[8:11], v6 offset:4096
    ds_read_b128 a[12:15], v7 offset:4096
    v_mfma_f32_32x32x16_bf16 v[32:47], a[24:27], a[40:43], v[32:47]
    v_mfma_f32_32x32x16_bf16 v[48:63], a[24:27], a[56:59], v[48:63]
    v_mfma_f32_32x32x16_bf16 v[32:47], a[28:31], a[44:47], v[32:47]
    v_mfma_f32_32x32x16_bf16 v[48:63], a[28:31], a[60:63], v[48:63]
    s_waitcnt lgkmcnt(0)
    v_mfma_f32_32x32x16_bf16 v[64:79], a[0:3], a[32:35], v[64:79]
    s_add_u32 m0, s64, 4096
    s_add_u32 s65, s7, 16384
    buffer_load_dwordx4 v1, s[24:27], s65 offen nt lds
    v_mfma_f32_32x32x16_bf16 v[80:95], a[0:3], a[48:51], v[80:95]
    s_add_u32 m0, s64, 5120
    s_add_u32 s65, s7, 20480
    buffer_load_dwordx4 v2, s[24:27], s65 offen nt lds
    v_mfma_f32_32x32x16_bf16 v[64:79], a[4:7], a[36:39], v[64:79]
    s_add_u32 m0, s64, 6144
    s_add_u32 s65, s7, 24576
    buffer_load_dwordx4 v1, s[24:27], s65 offen nt lds
    v_mfma_f32_32x32x16_bf16 v[80:95], a[4:7], a[52:55], v[80:95]
    s_add_u32 m0, s64, 7168
    s_add_u32 s65, s7, 28672
    buffer_load_dwordx4 v2, s[24:27], s65 offen nt lds
    s_waitcnt vmcnt(12)
    ds_read_b128 a[16:19], v4 offset:8192
    ds_read_b128 a[20:23], v5 offset:8192
    ds_read_b128 a[24:27], v6 offset:8192
    ds_read_b128 a[28:31], v7 offset:8192
    v_mfma_f32_32x32x16_bf16 v[64:79], a[8:11], a[40:43], v[64:79]
    v_mfma_f32_32x32x16_bf16 v[80:95], a[8:11], a[56:59], v[80:95]
    v_mfma_f32_32x32x16_bf16 v[64:79], a[12:15], a[44:47], v[64:79]
    v_mfma_f32_32x32x16_bf16 v[80:95], a[12:15], a[60:63], v[80:95]
    s_waitcnt lgkmcnt(0)
    v_mfma_f32_32x32x16_bf16 v[96:111], a[16:19], a[32:35], v[96:111]
    s_add_u32 m0, s64, 8192
    s_add_u32 s65, s7, 32768
    buffer_load_dwordx4 v1, s[24:27], s65 offen nt lds
    v_mfma_f32_32x32x16_bf16 v[112:127], a[16:19], a[48:51], v[112:127]
    s_add_u32 m0, s64, 9216
    s_add_u32 s65, s7, 36864
    buffer_load_dwordx4 v2, s[24:27], s65 offen nt lds
    v_mfma_f32_32x32x16_bf16 v[96:111], a[20:23], a[36:39], v[96:111]
    s_add_u32 m0, s64, 10240
    s_add_u32 s65, s7, 40960
    buffer_load_dwordx4 v1, s[24:27], s65 offen nt lds
    v_mfma_f32_32x32x16_bf16 v[112:127], a[20:23], a[52:55], v[112:127]
    s_add_u32 m0, s64, 11264
    s_add_u32 s65, s7, 45056
    buffer_load_dwordx4 v2, s[24:27], s65 offen nt lds
    s_waitcnt vmcnt(12)
    ds_read_b128 a[0:3], v4 offset:12288
    ds_read_b128 a[4:7], v5 offset:12288
    ds_read_b128 a[8:11], v6 offset:12288
    ds_read_b128 a[12:15], v7 offset:12288
    v_mfma_f32_32x32x16_bf16 v[96:111], a[24:27], a[40:43], v[96:111]
    v_mfma_f32_32x32x16_bf16 v[112:127], a[24:27], a[56:59], v[112:127]
    v_mfma_f32_32x32x16_bf16 v[96:111], a[28:31], a[44:47], v[96:111]
    v_mfma_f32_32x32x16_bf16 v[112:127], a[28:31], a[60:63], v[112:127]
    s_waitcnt lgkmcnt(0)
    v_mfma_f32_32x32x16_bf16 v[128:143], a[0:3], a[32:35], v[128:143]
    s_add_u32 m0, s64, 12288
    s_add_u32 s65, s7, 49152
    buffer_load_dwordx4 v1, s[24:27], s65 offen nt lds
    v_mfma_f32_32x32x16_bf16 v[144:159], a[0:3], a[48:51], v[144:159]
    s_add_u32 m0, s64, 13312
    s_add_u32 s65, s7, 53248
    buffer_load_dwordx4 v2, s[24:27], s65 offen nt lds
    v_mfma_f32_32x32x16_bf16 v[128:143], a[4:7], a[36:39], v[128:143]
    s_add_u32 m0, s64, 14336
    s_add_u32 s65, s7, 57344
    buffer_load_dwordx4 v1, s[24:27], s65 offen nt lds
    v_mfma_f32_32x32x16_bf16 v[144:159], a[4:7], a[52:55], v[144:159]
    s_add_u32 m0, s64, 15360
    s_add_u32 s65, s7, 61440
    buffer_load_dwordx4 v2, s[24:27], s65 offen nt lds
    v_add_u32 v28, s7, v14
    ds_read_b128 a[16:19], v28 offset:0
    ds_read_b128 a[20:23], v28 offset:32
    ds_read_b128 a[24:27], v28 offset:64
    ds_read_b128 a[28:31], v28 offset:96
    v_mfma_f32_32x32x16_bf16 v[128:143], a[8:11], a[40:43], v[128:143]
    v_mfma_f32_32x32x16_bf16 v[144:159], a[8:11], a[56:59], v[144:159]
    v_mfma_f32_32x32x16_bf16 v[128:143], a[12:15], a[44:47], v[128:143]
    v_mfma_f32_32x32x16_bf16 v[144:159], a[12:15], a[60:63], v[144:159]
    s_lshl_b32 s8, s7, 5
    v_add_u32 v24, s8, v8
    v_add_u32 v25, s8, v9
    v_add_u32 v26, s8, v10
    v_add_u32 v27, s8, v11
    ds_read_b128 a[32:35], v24 offset:0
    ds_read_b128 a[48:51], v24 offset:16384
    ds_read_b128 a[36:39], v25 offset:0
    ds_read_b128 a[52:55], v25 offset:16384
    ds_read_b128 a[40:43], v26 offset:0
    ds_read_b128 a[56:59], v26 offset:16384
    ds_read_b128 a[44:47], v27 offset:0
    ds_read_b128 a[60:63], v27 offset:16384
    s_waitcnt lgkmcnt(0)
    v_mfma_f32_32x32x16_bf16 a[64:79], a[16:19], a[32:35], a[64:79]
    v_mfma_f32_32x32x16_bf16 a[80:95], a[16:19], a[48:51], a[80:95]
    v_mfma_f32_32x32x16_bf16 a[64:79], a[20:23], a[36:39], a[64:79]
    v_mfma_f32_32x32x16_bf16 a[80:95], a[20:23], a[52:55], a[80:95]
    s_waitcnt vmcnt(12)
    ds_read_b128 a[0:3], v4 offset:0
    ds_read_b128 a[4:7], v5 offset:0
    ds_read_b128 a[8:11], v6 offset:0
    ds_read_b128 a[12:15], v7 offset:0
    v_mfma_f32_32x32x16_bf16 a[64:79], a[24:27], a[40:43], a[64:79]
    v_mfma_f32_32x32x16_bf16 a[80:95], a[24:27], a[56:59], a[80:95]
    v_mfma_f32_32x32x16_bf16 a[64:79], a[28:31], a[44:47], a[64:79]
    v_mfma_f32_32x32x16_bf16 a[80:95], a[28:31], a[60:63], a[80:95]
    s_waitcnt lgkmcnt(0)
    v_mfma_f32_32x32x16_bf16 v[32:47], a[0:3], a[32:35], v[32:47]
    s_add_u32 m0, s64, 0
    s_add_u32 s65, s66, 0
    buffer_load_dwordx4 v3, s[28:31], s65 offen nt lds
    v_mfma_f32_32x32x16_bf16 v[48:63], a[0:3], a[48:51], v[48:63]
    s_add_u32 m0, s64, 1024
    s_add_u32 s65, s66, 4096
    buffer_load_dwordx4 v3, s[28:31], s65 offen nt lds
    v_mfma_f32_32x32x16_bf16 v[32:47], a[4:7], a[36:39], v[32:47]
    s_add_u32 m0, s64, 2048
    s_add_u32 s65, s66, 8192
    buffer_load_dwordx4 v3, s[28:31], s65 offen nt lds
    v_mfma_f32_32x32x16_bf16 v[48:63], a[4:7], a[52:55], v[48:63]
    s_add_u32 m0, s64, 3072
    s_add_u32 s65, s66, 12288
    buffer_load_dwordx4 v3, s[28:31], s65 offen nt lds
    s_waitcnt vmcnt(12)
    ds_read_b128 a[16:19], v4 offset:4096
    ds_read_b128 a[20:23], v5 offset:4096
    ds_read_b128 a[24:27], v6 offset:4096
    ds_read_b128 a[28:31], v7 offset:4096
    v_mfma_f32_32x32x16_bf16 v[32:47], a[8:11], a[40:43], v[32:47]
    v_mfma_f32_32x32x16_bf16 v[48:63], a[8:11], a[56:59], v[48:63]
    v_mfma_f32_32x32x16_bf16 v[32:47], a[12:15], a[44:47], v[32:47]
    v_mfma_f32_32x32x16_bf16 v[48:63], a[12:15], a[60:63], v[48:63]
    s_waitcnt lgkmcnt(0)
    v_mfma_f32_32x32x16_bf16 v[64:79], a[16:19], a[32:35], v[64:79]
    s_add_u32 m0, s64, 4096
    s_add_u32 s65, s66, 16384
    buffer_load_dwordx4 v3, s[28:31], s65 offen nt lds
    v_mfma_f32_32x32x16_bf16 v[80:95], a[16:19], a[48:51], v[80:95]
    s_add_u32 m0, s64, 5120
    s_add_u32 s65, s66, 20480
    buffer_load_dwordx4 v3, s[28:31], s65 offen nt lds
    v_mfma_f32_32x32x16_bf16 v[64:79], a[20:23], a[36:39], v[64:79]
    s_add_u32 m0, s64, 6144
    s_add_u32 s65, s66, 24576
    buffer_load_dwordx4 v3, s[28:31], s65 offen nt lds
    v_mfma_f32_32x32x16_bf16 v[80:95], a[20:23], a[52:55], v[80:95]
    s_add_u32 m0, s64, 7168
    s_add_u32 s65, s66, 28672
    buffer_load_dwordx4 v3, s[28:31], s65 offen nt lds
    s_waitcnt vmcnt(12)
    ds_read_b128 a[0:3], v4 offset:8192
    ds_read_b128 a[4:7], v5 offset:8192
    ds_read_b128 a[8:11], v6 offset:8192
    ds_read_b128 a[12:15], v7 offset:8192
    v_mfma_f32_32x32x16_bf16 v[64:79], a[24:27], a[40:43], v[64:79]
    v_mfma_f32_32x32x16_bf16 v[80:95], a[24:27], a[56:59], v[80:95]
    v_mfma_f32_32x32x16_bf16 v[64:79], a[28:31], a[44:47], v[64:79]
    v_mfma_f32_32x32x16_bf16 v[80:95], a[28:31], a[60:63], v[80:95]
    s_waitcnt lgkmcnt(0)
    v_mfma_f32_32x32x16_bf16 v[96:111], a[0:3], a[32:35], v[96:111]
    s_add_u32 m0, s64, 8192
    s_add_u32 s65, s66, 32768
    buffer_load_dwordx4 v3, s[28:31], s65 offen nt lds
    v_mfma_f32_32x32x16_bf16 v[112:127], a[0:3], a[48:51], v[112:127]
    s_add_u32 m0, s64, 9216
    s_add_u32 s65, s66, 36864
    buffer_load_dwordx4 v3, s[28:31], s65 offen nt lds
    v_mfma_f32_32x32x16_bf16 v[96:111], a[4:7], a[36:39], v[96:111]
    s_add_u32 m0, s64, 10240
    s_add_u32 s65, s66, 40960
    buffer_load_dwordx4 v3, s[28:31], s65 offen nt lds
    v_mfma_f32_32x32x16_bf16 v[112:127], a[4:7], a[52:55], v[112:127]
    s_add_u32 m0, s64, 11264
    s_add_u32 s65, s66, 45056
    buffer_load_dwordx4 v3, s[28:31], s65 offen nt lds
    s_waitcnt vmcnt(12)
    ds_read_b128 a[16:19], v4 offset:12288
    ds_read_b128 a[20:23], v5 offset:12288
    ds_read_b128 a[24:27], v6 offset:12288
    ds_read_b128 a[28:31], v7 offset:12288
    v_mfma_f32_32x32x16_bf16 v[96:111], a[8:11], a[40:43], v[96:111]
    v_mfma_f32_32x32x16_bf16 v[112:127], a[8:11], a[56:59], v[112:127]
    v_mfma_f32_32x32x16_bf16 v[96:111], a[12:15], a[44:47], v[96:111]
    v_mfma_f32_32x32x16_bf16 v[112:127], a[12:15], a[60:63], v[112:127]
    s_waitcnt lgkmcnt(0)
    v_mfma_f32_32x32x16_bf16 v[128:143], a[16:19], a[32:35], v[128:143]
    s_add_u32 m0, s64, 12288
    s_add_u32 s65, s66, 49152
    buffer_load_dwordx4 v3, s[28:31], s65 offen nt lds
    v_mfma_f32_32x32x16_bf16 v[144:159], a[16:19], a[48:51], v[144:159]
    s_add_u32 m0, s64, 13312
    s_add_u32 s65, s66, 53248
    buffer_load_dwordx4 v3, s[28:31], s65 offen nt lds
    v_mfma_f32_32x32x16_bf16 v[128:143], a[20:23], a[36:39], v[128:143]
    s_add_u32 m0, s64, 14336
    s_add_u32 s65, s66, 57344
    buffer_load_dwordx4 v3, s[28:31], s65 offen nt lds
    v_mfma_f32_32x32x16_bf16 v[144:159], a[20:23], a[52:55], v[144:159]
    s_add_u32 m0, s64, 15360
    s_add_u32 s65, s66, 61440
    buffer_load_dwordx4 v3, s[28:31], s65 offen nt lds
    v_mfma_f32_32x32x16_bf16 v[128:143], a[24:27], a[40:43], v[128:143]
    v_mfma_f32_32x32x16_bf16 v[144:159], a[24:27], a[56:59], v[144:159]
    v_mfma_f32_32x32x16_bf16 v[128:143], a[28:31], a[44:47], v[128:143]
    v_mfma_f32_32x32x16_bf16 v[144:159], a[28:31], a[60:63], v[144:159]
    s_mov_b64 exec, 1
    ds_add_u32 v16, v19 offset:8
    s_mov_b64 exec, -1
    s_nop 7
    v_accvgpr_read_b32 v22, a64
    v_accvgpr_read_b32 v23, a65
    v_accvgpr_read_b32 v24, a80
    v_accvgpr_read_b32 v25, a81
    v_add_f32 v22, v22, v20
    v_add_f32 v23, v23, v21
    v_add_f32 v24, v24, v20
    v_add_f32 v25, v25, v21
    v_add_u32 v14, s66, v15
    ds_read_b64_tr_b16 a[64:65], v14 offset:0
    ds_read_b64_tr_b16 a[66:67], v14 offset:0
    ds_read_b64_tr_b16 a[68:69], v14 offset:64
    ds_read_b64_tr_b16 a[70:71], v14 offset:64
    s_nop 3
    v_max_f32 v26, v22, v23
    v_max_f32 v30, v32, v33
    v_max3_f32 v26, v26, v34, v35
    v_max3_f32 v30, v30, v36, v37
    v_max3_f32 v26, v26, v38, v39
    v_max3_f32 v30, v30, v40, v41
    v_max3_f32 v26, v26, v42, v43
    v_max3_f32 v30, v30, v44, v45
    v_max3_f32 v26, v26, v46, v47
    v_max3_f32 v30, v30, v64, v65
    v_max3_f32 v26, v26, v66, v67
    v_max3_f32 v30, v30, v68, v69
    v_max3_f32 v26, v26, v70, v71
    v_max3_f32 v30, v30, v72, v73
    v_max3_f32 v26, v26, v74, v75
    v_max3_f32 v30, v30, v76, v77
    v_max3_f32 v26, v26, v78, v79
    v_max3_f32 v30, v30, v96, v97
    v_max3_f32 v26, v26, v98, v99
    v_max3_f32 v30, v30, v100, v101
    v_max3_f32 v26, v26, v102, v103
    v_max3_f32 v30, v30, v104, v105
    v_max3_f32 v26, v26, v106, v107
    v_max3_f32 v30, v30, v108, v109
    v_max3_f32 v26, v26, v110, v111
    v_max3_f32 v30, v30, v128, v129
    v_max3_f32 v26, v26, v130, v131
    v_max3_f32 v30, v30, v132, v133
    v_max3_f32 v26, v26, v134, v135
    v_max3_f32 v30, v30, v136, v137
    v_max3_f32 v26, v26, v138, v139
    v_max3_f32 v30, v30, v140, v141
    v_max3_f32 v26, v26, v142, v143
    v_max_f32 v26, v26, v30
    v_mov_b32 v30, v26
    s_nop 1
    v_permlane32_swap_b32 v30, v26
    s_nop 1
    v_max_f32 v26, v26, v30
    v_max_f32 v27, v24, v25
    v_max_f32 v30, v48, v49
    v_max3_f32 v27, v27, v50, v51
    v_max3_f32 v30, v30, v52, v53
    v_max3_f32 v27, v27, v54, v55
    v_max3_f32 v30, v30, v56, v57
    v_max3_f32 v27, v27, v58, v59
    v_max3_f32 v30, v30, v60, v61
    v_max3_f32 v27, v27, v62, v63
    v_max3_f32 v30, v30, v80, v81
    v_max3_f32 v27, v27, v82, v83
    v_max3_f32 v30, v30, v84, v85
    v_max3_f32 v27, v27, v86, v87
    v_max3_f32 v30, v30, v88, v89
    v_max3_f32 v27, v27, v90, v91
    v_max3_f32 v30, v30, v92, v93
    v_max3_f32 v27, v27, v94, v95
    v_max3_f32 v30, v30, v112, v113
    v_max3_f32 v27, v27, v114, v115
    v_max3_f32 v30, v30, v116, v117
    v_max3_f32 v27, v27, v118, v119
    v_max3_f32 v30, v30, v120, v121
    v_max3_f32 v27, v27, v122, v123
    v_max3_f32 v30, v30, v124, v125
    v_max3_f32 v27, v27, v126, v127
    v_max3_f32 v30, v30, v144, v145
    v_max3_f32 v27, v27, v146, v147
    v_max3_f32 v30, v30, v148, v149
    v_max3_f32 v27, v27, v150, v151
    v_max3_f32 v30, v30, v152, v153
    v_max3_f32 v27, v27, v154, v155
    v_max3_f32 v30, v30, v156, v157
    v_max3_f32 v27, v27, v158, v159
    v_max_f32 v27, v27, v30
    v_mov_b32 v30, v27
    s_nop 1
    v_permlane32_swap_b32 v30, v27
    s_nop 1
    v_max_f32 v27, v27, v30
    v_mov_b32 v20, v26
    v_mov_b32 v28, v27
    v_mul_f32 v26, s77, v26
    v_mul_f32 v27, s77, v27
    v_mov_b32 v4, 0
    v_mov_b32 v5, 0
    v_mov_b32 v6, 0
    v_mov_b32 v7, 0
    v_mov_b32 v8, 0
    v_mov_b32 v9, 0
    v_mov_b32 v10, 0
    v_mov_b32 v11, 0
    s_mov_b32 s84, s77
    s_mov_b32 s85, s77
    v_fma_f32 v22, v22, s77, -v26
    v_fma_f32 v23, v23, s77, -v26
    v_exp_f32 v22, v22
    v_exp_f32 v23, v23
    s_nop 0
    v_add_f32 v21, v22, v23
    v_cvt_pk_bf16_f32 v4, v22, v23
    v_fma_f32 v24, v24, s77, -v27
    v_fma_f32 v25, v25, s77, -v27
    v_exp_f32 v24, v24
    v_exp_f32 v25, v25
    s_nop 0
    v_add_f32 v29, v24, v25
    v_cvt_pk_bf16_f32 v8, v24, v25
    v_pk_fma_f32 v[32:33], v[32:33], s[84:85], v[26:27] op_sel:[0,0,0] op_sel_hi:[1,1,0] neg_lo:[0,0,1] neg_hi:[0,0,1]
    v_pk_fma_f32 v[34:35], v[34:35], s[84:85], v[26:27] op_sel:[0,0,0] op_sel_hi:[1,1,0] neg_lo:[0,0,1] neg_hi:[0,0,1]
    v_pk_fma_f32 v[36:37], v[36:37], s[84:85], v[26:27] op_sel:[0,0,0] op_sel_hi:[1,1,0] neg_lo:[0,0,1] neg_hi:[0,0,1]
    v_pk_fma_f32 v[38:39], v[38:39], s[84:85], v[26:27] op_sel:[0,0,0] op_sel_hi:[1,1,0] neg_lo:[0,0,1] neg_hi:[0,0,1]
    v_pk_fma_f32 v[40:41], v[40:41], s[84:85], v[26:27] op_sel:[0,0,0] op_sel_hi:[1,1,0] neg_lo:[0,0,1] neg_hi:[0,0,1]
    v_pk_fma_f32 v[42:43], v[42:43], s[84:85], v[26:27] op_sel:[0,0,0] op_sel_hi:[1,1,0] neg_lo:[0,0,1] neg_hi:[0,0,1]
    v_pk_fma_f32 v[44:45], v[44:45], s[84:85], v[26:27] op_sel:[0,0,0] op_sel_hi:[1,1,0] neg_lo:[0,0,1] neg_hi:[0,0,1]
    v_pk_fma_f32 v[46:47], v[46:47], s[84:85], v[26:27] op_sel:[0,0,0] op_sel_hi:[1,1,0] neg_lo:[0,0,1] neg_hi:[0,0,1]
    v_exp_f32 v32, v32
    v_exp_f32 v33, v33
    v_exp_f32 v34, v34
    v_exp_f32 v35, v35
    v_exp_f32 v36, v36
    v_exp_f32 v37, v37
    v_exp_f32 v38, v38
    v_exp_f32 v39, v39
    v_exp_f32 v40, v40
    v_exp_f32 v41, v41
    v_exp_f32 v42, v42
    v_exp_f32 v43, v43
    v_exp_f32 v44, v44
    v_exp_f32 v45, v45
    v_exp_f32 v46, v46
    v_exp_f32 v47, v47
    v_pk_add_f32 v[30:31], v[32:33], v[34:35]
    v_pk_add_f32 v[22:23], v[36:37], v[38:39]
    v_pk_add_f32 v[30:31], v[30:31], v[40:41]
    v_pk_add_f32 v[22:23], v[22:23], v[42:43]
    v_pk_add_f32 v[30:31], v[30:31], v[44:45]
    v_pk_add_f32 v[22:23], v[22:23], v[46:47]
    v_cvt_pk_bf16_f32 v32, v32, v33
    v_cvt_pk_bf16_f32 v33, v34, v35
    v_cvt_pk_bf16_f32 v34, v36, v37
    v_cvt_pk_bf16_f32 v35, v38, v39
    v_cvt_pk_bf16_f32 v36, v40, v41
    v_cvt_pk_bf16_f32 v37, v42, v43
    v_cvt_pk_bf16_f32 v38, v44, v45
    v_cvt_pk_bf16_f32 v39, v46, v47
    v_pk_add_f32 v[30:31], v[30:31], v[22:23]
    v_add_f32 v30, v30, v31
    v_add_f32 v21, v21, v30
    v_pk_fma_f32 v[48:49], v[48:49], s[84:85], v[26:27] op_sel:[0,0,1] op_sel_hi:[1,1,1] neg_lo:[0,0,1] neg_hi:[0,0,1]
    v_pk_fma_f32 v[50:51], v[50:51], s[84:85], v[26:27] op_sel:[0,0,1] op_sel_hi:[1,1,1] neg_lo:[0,0,1] neg_hi:[0,0,1]
    v_pk_fma_f32 v[52:53], v[52:53], s[84:85], v[26:27] op_sel:[0,0,1] op_sel_hi:[1,1,1] neg_lo:[0,0,1] neg_hi:[0,0,1]
    v_pk_fma_f32 v[54:55], v[54:55], s[84:85], v[26:27] op_sel:[0,0,1] op_sel_hi:[1,1,1] neg_lo:[0,0,1] neg_hi:[0,0,1]
    v_pk_fma_f32 v[56:57], v[56:57], s[84:85], v[26:27] op_sel:[0,0,1] op_sel_hi:[1,1,1] neg_lo:[0,0,1] neg_hi:[0,0,1]
    v_pk_fma_f32 v[58:59], v[58:59], s[84:85], v[26:27] op_sel:[0,0,1] op_sel_hi:[1,1,1] neg_lo:[0,0,1] neg_hi:[0,0,1]
    v_pk_fma_f32 v[60:61], v[60:61], s[84:85], v[26:27] op_sel:[0,0,1] op_sel_hi:[1,1,1] neg_lo:[0,0,1] neg_hi:[0,0,1]
    v_pk_fma_f32 v[62:63], v[62:63], s[84:85], v[26:27] op_sel:[0,0,1] op_sel_hi:[1,1,1] neg_lo:[0,0,1] neg_hi:[0,0,1]
    v_exp_f32 v48, v48
    v_exp_f32 v49, v49
    v_exp_f32 v50, v50
    v_exp_f32 v51, v51
    v_exp_f32 v52, v52
    v_exp_f32 v53, v53
    v_exp_f32 v54, v54
    v_exp_f32 v55, v55
    v_exp_f32 v56, v56
    v_exp_f32 v57, v57
    v_exp_f32 v58, v58
    v_exp_f32 v59, v59
    v_exp_f32 v60, v60
    v_exp_f32 v61, v61
    v_exp_f32 v62, v62
    v_exp_f32 v63, v63
    v_pk_add_f32 v[30:31], v[48:49], v[50:51]
    v_pk_add_f32 v[22:23], v[52:53], v[54:55]
    v_pk_add_f32 v[30:31], v[30:31], v[56:57]
    v_pk_add_f32 v[22:23], v[22:23], v[58:59]
    v_pk_add_f32 v[30:31], v[30:31], v[60:61]
    v_pk_add_f32 v[22:23], v[22:23], v[62:63]
    v_cvt_pk_bf16_f32 v48, v48, v49
    v_cvt_pk_bf16_f32 v49, v50, v51
    v_cvt_pk_bf16_f32 v50, v52, v53
    v_cvt_pk_bf16_f32 v51, v54, v55
    v_cvt_pk_bf16_f32 v52, v56, v57
    v_cvt_pk_bf16_f32 v53, v58, v59
    v_cvt_pk_bf16_f32 v54, v60, v61
    v_cvt_pk_bf16_f32 v55, v62, v63
    v_pk_add_f32 v[30:31], v[30:31], v[22:23]
    v_add_f32 v30, v30, v31
    v_add_f32 v29, v29, v30
    s_waitcnt lgkmcnt(0)
    s_waitcnt vmcnt(12)
    ds_read_b64_tr_b16 a[80:81], v12 offset:0
    ds_read_b64_tr_b16 a[82:83], v12 offset:1024
    ds_read_b64_tr_b16 a[84:85], v13 offset:0
    ds_read_b64_tr_b16 a[86:87], v13 offset:1024
    ds_read_b64_tr_b16 a[88:89], v12 offset:2048
    ds_read_b64_tr_b16 a[90:91], v12 offset:3072
    ds_read_b64_tr_b16 a[92:93], v13 offset:2048
    ds_read_b64_tr_b16 a[94:95], v13 offset:3072
    v_mfma_f32_32x32x16_bf16 a[0:15], a[64:67], v[4:7], 0
    v_mfma_f32_32x32x16_bf16 a[16:31], a[64:67], v[8:11], 0
    v_mfma_f32_32x32x16_bf16 a[32:47], a[68:71], v[4:7], 0
    v_mfma_f32_32x32x16_bf16 a[48:63], a[68:71], v[8:11], 0
    s_waitcnt lgkmcnt(0)
    v_mfma_f32_32x32x16_bf16 a[0:15], a[80:83], v[32:35], a[0:15]
    s_add_u32 m0, s64, 0
    s_add_u32 s65, s67, 0
    buffer_load_dwordx4 v3, s[28:31], s65 offen nt lds
    v_mfma_f32_32x32x16_bf16 a[16:31], a[80:83], v[48:51], a[16:31]
    s_add_u32 m0, s64, 1024
    s_add_u32 s65, s67, 4096
    buffer_load_dwordx4 v3, s[28:31], s65 offen nt lds
    v_mfma_f32_32x32x16_bf16 a[32:47], a[84:87], v[32:35], a[32:47]
    s_add_u32 m0, s64, 2048
    s_add_u32 s65, s67, 8192
    buffer_load_dwordx4 v3, s[28:31], s65 offen nt lds
    v_mfma_f32_32x32x16_bf16 a[48:63], a[84:87], v[48:51], a[48:63]
    s_add_u32 m0, s64, 3072
    s_add_u32 s65, s67, 12288
    buffer_load_dwordx4 v3, s[28:31], s65 offen nt lds
    s_waitcnt vmcnt(12)
    ds_read_b64_tr_b16 a[64:65], v12 offset:4096
    ds_read_b64_tr_b16 a[66:67], v12 offset:5120
    ds_read_b64_tr_b16 a[68:69], v13 offset:4096
    ds_read_b64_tr_b16 a[70:71], v13 offset:5120
    ds_read_b64_tr_b16 a[72:73], v12 offset:6144
    ds_read_b64_tr_b16 a[74:75], v12 offset:7168
    ds_read_b64_tr_b16 a[76:77], v13 offset:6144
    ds_read_b64_tr_b16 a[78:79], v13 offset:7168
    v_mfma_f32_32x32x16_bf16 a[0:15], a[88:91], v[36:39], a[0:15]
    v_mfma_f32_32x32x16_bf16 a[16:31], a[88:91], v[52:55], a[16:31]
    v_mfma_f32_32x32x16_bf16 a[32:47], a[92:95], v[36:39], a[32:47]
    v_mfma_f32_32x32x16_bf16 a[48:63], a[92:95], v[52:55], a[48:63]
    v_pk_fma_f32 v[64:65], v[64:65], s[84:85], v[26:27] op_sel:[0,0,0] op_sel_hi:[1,1,0] neg_lo:[0,0,1] neg_hi:[0,0,1]
    v_pk_fma_f32 v[66:67], v[66:67], s[84:85], v[26:27] op_sel:[0,0,0] op_sel_hi:[1,1,0] neg_lo:[0,0,1] neg_hi:[0,0,1]
    v_pk_fma_f32 v[68:69], v[68:69], s[84:85], v[26:27] op_sel:[0,0,0] op_sel_hi:[1,1,0] neg_lo:[0,0,1] neg_hi:[0,0,1]
    v_pk_fma_f32 v[70:71], v[70:71], s[84:85], v[26:27] op_sel:[0,0,0] op_sel_hi:[1,1,0] neg_lo:[0,0,1] neg_hi:[0,0,1]
    v_pk_fma_f32 v[72:73], v[72:73], s[84:85], v[26:27] op_sel:[0,0,0] op_sel_hi:[1,1,0] neg_lo:[0,0,1] neg_hi:[0,0,1]
    v_pk_fma_f32 v[74:75], v[74:75], s[84:85], v[26:27] op_sel:[0,0,0] op_sel_hi:[1,1,0] neg_lo:[0,0,1] neg_hi:[0,0,1]
    v_pk_fma_f32 v[76:77], v[76:77], s[84:85], v[26:27] op_sel:[0,0,0] op_sel_hi:[1,1,0] neg_lo:[0,0,1] neg_hi:[0,0,1]
    v_pk_fma_f32 v[78:79], v[78:79], s[84:85], v[26:27] op_sel:[0,0,0] op_sel_hi:[1,1,0] neg_lo:[0,0,1] neg_hi:[0,0,1]
    v_exp_f32 v64, v64
    v_exp_f32 v65, v65
    v_exp_f32 v66, v66
    v_exp_f32 v67, v67
    v_exp_f32 v68, v68
    v_exp_f32 v69, v69
    v_exp_f32 v70, v70
    v_exp_f32 v71, v71
    v_exp_f32 v72, v72
    v_exp_f32 v73, v73
    v_exp_f32 v74, v74
    v_exp_f32 v75, v75
    v_exp_f32 v76, v76
    v_exp_f32 v77, v77
    v_exp_f32 v78, v78
    v_exp_f32 v79, v79
    v_pk_add_f32 v[30:31], v[64:65], v[66:67]
    v_pk_add_f32 v[22:23], v[68:69], v[70:71]
    v_pk_add_f32 v[30:31], v[30:31], v[72:73]
    v_pk_add_f32 v[22:23], v[22:23], v[74:75]
    v_pk_add_f32 v[30:31], v[30:31], v[76:77]
    v_pk_add_f32 v[22:23], v[22:23], v[78:79]
    v_cvt_pk_bf16_f32 v64, v64, v65
    v_cvt_pk_bf16_f32 v65, v66, v67
    v_cvt_pk_bf16_f32 v66, v68, v69
    v_cvt_pk_bf16_f32 v67, v70, v71
    v_cvt_pk_bf16_f32 v68, v72, v73
    v_cvt_pk_bf16_f32 v69, v74, v75
    v_cvt_pk_bf16_f32 v70, v76, v77
    v_cvt_pk_bf16_f32 v71, v78, v79
    v_pk_add_f32 v[30:31], v[30:31], v[22:23]
    v_add_f32 v30, v30, v31
    v_add_f32 v21, v21, v30
    v_pk_fma_f32 v[80:81], v[80:81], s[84:85], v[26:27] op_sel:[0,0,1] op_sel_hi:[1,1,1] neg_lo:[0,0,1] neg_hi:[0,0,1]
    v_pk_fma_f32 v[82:83], v[82:83], s[84:85], v[26:27] op_sel:[0,0,1] op_sel_hi:[1,1,1] neg_lo:[0,0,1] neg_hi:[0,0,1]
    v_pk_fma_f32 v[84:85], v[84:85], s[84:85], v[26:27] op_sel:[0,0,1] op_sel_hi:[1,1,1] neg_lo:[0,0,1] neg_hi:[0,0,1]
    v_pk_fma_f32 v[86:87], v[86:87], s[84:85], v[26:27] op_sel:[0,0,1] op_sel_hi:[1,1,1] neg_lo:[0,0,1] neg_hi:[0,0,1]
    v_pk_fma_f32 v[88:89], v[88:89], s[84:85], v[26:27] op_sel:[0,0,1] op_sel_hi:[1,1,1] neg_lo:[0,0,1] neg_hi:[0,0,1]
    v_pk_fma_f32 v[90:91], v[90:91], s[84:85], v[26:27] op_sel:[0,0,1] op_sel_hi:[1,1,1] neg_lo:[0,0,1] neg_hi:[0,0,1]
    v_pk_fma_f32 v[92:93], v[92:93], s[84:85], v[26:27] op_sel:[0,0,1] op_sel_hi:[1,1,1] neg_lo:[0,0,1] neg_hi:[0,0,1]
    v_pk_fma_f32 v[94:95], v[94:95], s[84:85], v[26:27] op_sel:[0,0,1] op_sel_hi:[1,1,1] neg_lo:[0,0,1] neg_hi:[0,0,1]
    v_exp_f32 v80, v80
    v_exp_f32 v81, v81
    v_exp_f32 v82, v82
    v_exp_f32 v83, v83
    v_exp_f32 v84, v84
    v_exp_f32 v85, v85
    v_exp_f32 v86, v86
    v_exp_f32 v87, v87
    v_exp_f32 v88, v88
    v_exp_f32 v89, v89
    v_exp_f32 v90, v90
    v_exp_f32 v91, v91
    v_exp_f32 v92, v92
    v_exp_f32 v93, v93
    v_exp_f32 v94, v94
    v_exp_f32 v95, v95
    v_pk_add_f32 v[30:31], v[80:81], v[82:83]
    v_pk_add_f32 v[22:23], v[84:85], v[86:87]
    v_pk_add_f32 v[30:31], v[30:31], v[88:89]
    v_pk_add_f32 v[22:23], v[22:23], v[90:91]
    v_pk_add_f32 v[30:31], v[30:31], v[92:93]
    v_pk_add_f32 v[22:23], v[22:23], v[94:95]
    v_cvt_pk_bf16_f32 v80, v80, v81
    v_cvt_pk_bf16_f32 v81, v82, v83
    v_cvt_pk_bf16_f32 v82, v84, v85
    v_cvt_pk_bf16_f32 v83, v86, v87
    v_cvt_pk_bf16_f32 v84, v88, v89
    v_cvt_pk_bf16_f32 v85, v90, v91
    v_cvt_pk_bf16_f32 v86, v92, v93
    v_cvt_pk_bf16_f32 v87, v94, v95
    v_pk_add_f32 v[30:31], v[30:31], v[22:23]
    v_add_f32 v30, v30, v31
    v_add_f32 v29, v29, v30
    s_waitcnt lgkmcnt(0)
    v_mfma_f32_32x32x16_bf16 a[0:15], a[64:67], v[64:67], a[0:15]
    s_add_u32 m0, s64, 4096
    s_add_u32 s65, s67, 16384
    buffer_load_dwordx4 v3, s[28:31], s65 offen nt lds
    v_mfma_f32_32x32x16_bf16 a[16:31], a[64:67], v[80:83], a[16:31]
    s_add_u32 m0, s64, 5120
    s_add_u32 s65, s67, 20480
    buffer_load_dwordx4 v3, s[28:31], s65 offen nt lds
    v_mfma_f32_32x32x16_bf16 a[32:47], a[68:71], v[64:67], a[32:47]
    s_add_u32 m0, s64, 6144
    s_add_u32 s65, s67, 24576
    buffer_load_dwordx4 v3, s[28:31], s65 offen nt lds
    v_mfma_f32_32x32x16_bf16 a[48:63], a[68:71], v[80:83], a[48:63]
    s_add_u32 m0, s64, 7168
    s_add_u32 s65, s67, 28672
    buffer_load_dwordx4 v3, s[28:31], s65 offen nt lds
    s_waitcnt vmcnt(12)
    ds_read_b64_tr_b16 a[80:81], v12 offset:8192
    ds_read_b64_tr_b16 a[82:83], v12 offset:9216
    ds_read_b64_tr_b16 a[84:85], v13 offset:8192
    ds_read_b64_tr_b16 a[86:87], v13 offset:9216
    ds_read_b64_tr_b16 a[88:89], v12 offset:10240
    ds_read_b64_tr_b16 a[90:91], v12 offset:11264
    ds_read_b64_tr_b16 a[92:93], v13 offset:10240
    ds_read_b64_tr_b16 a[94:95], v13 offset:11264
    v_mfma_f32_32x32x16_bf16 a[0:15], a[72:75], v[68:71], a[0:15]
    v_mfma_f32_32x32x16_bf16 a[16:31], a[72:75], v[84:87], a[16:31]
    v_mfma_f32_32x32x16_bf16 a[32:47], a[76:79], v[68:71], a[32:47]
    v_mfma_f32_32x32x16_bf16 a[48:63], a[76:79], v[84:87], a[48:63]
    v_pk_fma_f32 v[96:97], v[96:97], s[84:85], v[26:27] op_sel:[0,0,0] op_sel_hi:[1,1,0] neg_lo:[0,0,1] neg_hi:[0,0,1]
    v_pk_fma_f32 v[98:99], v[98:99], s[84:85], v[26:27] op_sel:[0,0,0] op_sel_hi:[1,1,0] neg_lo:[0,0,1] neg_hi:[0,0,1]
    v_pk_fma_f32 v[100:101], v[100:101], s[84:85], v[26:27] op_sel:[0,0,0] op_sel_hi:[1,1,0] neg_lo:[0,0,1] neg_hi:[0,0,1]
    v_pk_fma_f32 v[102:103], v[102:103], s[84:85], v[26:27] op_sel:[0,0,0] op_sel_hi:[1,1,0] neg_lo:[0,0,1] neg_hi:[0,0,1]
    v_pk_fma_f32 v[104:105], v[104:105], s[84:85], v[26:27] op_sel:[0,0,0] op_sel_hi:[1,1,0] neg_lo:[0,0,1] neg_hi:[0,0,1]
    v_pk_fma_f32 v[106:107], v[106:107], s[84:85], v[26:27] op_sel:[0,0,0] op_sel_hi:[1,1,0] neg_lo:[0,0,1] neg_hi:[0,0,1]
    v_pk_fma_f32 v[108:109], v[108:109], s[84:85], v[26:27] op_sel:[0,0,0] op_sel_hi:[1,1,0] neg_lo:[0,0,1] neg_hi:[0,0,1]
    v_pk_fma_f32 v[110:111], v[110:111], s[84:85], v[26:27] op_sel:[0,0,0] op_sel_hi:[1,1,0] neg_lo:[0,0,1] neg_hi:[0,0,1]
    v_exp_f32 v96, v96
    v_exp_f32 v97, v97
    v_exp_f32 v98, v98
    v_exp_f32 v99, v99
    v_exp_f32 v100, v100
    v_exp_f32 v101, v101
    v_exp_f32 v102, v102
    v_exp_f32 v103, v103
    v_exp_f32 v104, v104
    v_exp_f32 v105, v105
    v_exp_f32 v106, v106
    v_exp_f32 v107, v107
    v_exp_f32 v108, v108
    v_exp_f32 v109, v109
    v_exp_f32 v110, v110
    v_exp_f32 v111, v111
    v_pk_add_f32 v[30:31], v[96:97], v[98:99]
    v_pk_add_f32 v[22:23], v[100:101], v[102:103]
    v_pk_add_f32 v[30:31], v[30:31], v[104:105]
    v_pk_add_f32 v[22:23], v[22:23], v[106:107]
    v_pk_add_f32 v[30:31], v[30:31], v[108:109]
    v_pk_add_f32 v[22:23], v[22:23], v[110:111]
    v_cvt_pk_bf16_f32 v96, v96, v97
    v_cvt_pk_bf16_f32 v97, v98, v99
    v_cvt_pk_bf16_f32 v98, v100, v101
    v_cvt_pk_bf16_f32 v99, v102, v103
    v_cvt_pk_bf16_f32 v100, v104, v105
    v_cvt_pk_bf16_f32 v101, v106, v107
    v_cvt_pk_bf16_f32 v102, v108, v109
    v_cvt_pk_bf16_f32 v103, v110, v111
    v_pk_add_f32 v[30:31], v[30:31], v[22:23]
    v_add_f32 v30, v30, v31
    v_add_f32 v21, v21, v30
    v_pk_fma_f32 v[112:113], v[112:113], s[84:85], v[26:27] op_sel:[0,0,1] op_sel_hi:[1,1,1] neg_lo:[0,0,1] neg_hi:[0,0,1]
    v_pk_fma_f32 v[114:115], v[114:115], s[84:85], v[26:27] op_sel:[0,0,1] op_sel_hi:[1,1,1] neg_lo:[0,0,1] neg_hi:[0,0,1]
    v_pk_fma_f32 v[116:117], v[116:117], s[84:85], v[26:27] op_sel:[0,0,1] op_sel_hi:[1,1,1] neg_lo:[0,0,1] neg_hi:[0,0,1]
    v_pk_fma_f32 v[118:119], v[118:119], s[84:85], v[26:27] op_sel:[0,0,1] op_sel_hi:[1,1,1] neg_lo:[0,0,1] neg_hi:[0,0,1]
    v_pk_fma_f32 v[120:121], v[120:121], s[84:85], v[26:27] op_sel:[0,0,1] op_sel_hi:[1,1,1] neg_lo:[0,0,1] neg_hi:[0,0,1]
    v_pk_fma_f32 v[122:123], v[122:123], s[84:85], v[26:27] op_sel:[0,0,1] op_sel_hi:[1,1,1] neg_lo:[0,0,1] neg_hi:[0,0,1]
    v_pk_fma_f32 v[124:125], v[124:125], s[84:85], v[26:27] op_sel:[0,0,1] op_sel_hi:[1,1,1] neg_lo:[0,0,1] neg_hi:[0,0,1]
    v_pk_fma_f32 v[126:127], v[126:127], s[84:85], v[26:27] op_sel:[0,0,1] op_sel_hi:[1,1,1] neg_lo:[0,0,1] neg_hi:[0,0,1]
    v_exp_f32 v112, v112
    v_exp_f32 v113, v113
    v_exp_f32 v114, v114
    v_exp_f32 v115, v115
    v_exp_f32 v116, v116
    v_exp_f32 v117, v117
    v_exp_f32 v118, v118
    v_exp_f32 v119, v119
    v_exp_f32 v120, v120
    v_exp_f32 v121, v121
    v_exp_f32 v122, v122
    v_exp_f32 v123, v123
    v_exp_f32 v124, v124
    v_exp_f32 v125, v125
    v_exp_f32 v126, v126
    v_exp_f32 v127, v127
    v_pk_add_f32 v[30:31], v[112:113], v[114:115]
    v_pk_add_f32 v[22:23], v[116:117], v[118:119]
    v_pk_add_f32 v[30:31], v[30:31], v[120:121]
    v_pk_add_f32 v[22:23], v[22:23], v[122:123]
    v_pk_add_f32 v[30:31], v[30:31], v[124:125]
    v_pk_add_f32 v[22:23], v[22:23], v[126:127]
    v_cvt_pk_bf16_f32 v112, v112, v113
    v_cvt_pk_bf16_f32 v113, v114, v115
    v_cvt_pk_bf16_f32 v114, v116, v117
    v_cvt_pk_bf16_f32 v115, v118, v119
    v_cvt_pk_bf16_f32 v116, v120, v121
    v_cvt_pk_bf16_f32 v117, v122, v123
    v_cvt_pk_bf16_f32 v118, v124, v125
    v_cvt_pk_bf16_f32 v119, v126, v127
    v_pk_add_f32 v[30:31], v[30:31], v[22:23]
    v_add_f32 v30, v30, v31
    v_add_f32 v29, v29, v30
    s_waitcnt lgkmcnt(0)
    v_mfma_f32_32x32x16_bf16 a[0:15], a[80:83], v[96:99], a[0:15]
    s_add_u32 m0, s64, 8192
    s_add_u32 s65, s67, 32768
    buffer_load_dwordx4 v3, s[28:31], s65 offen nt lds
    v_mfma_f32_32x32x16_bf16 a[16:31], a[80:83], v[112:115], a[16:31]
    s_add_u32 m0, s64, 9216
    s_add_u32 s65, s67, 36864
    buffer_load_dwordx4 v3, s[28:31], s65 offen nt lds
    v_mfma_f32_32x32x16_bf16 a[32:47], a[84:87], v[96:99], a[32:47]
    s_add_u32 m0, s64, 10240
    s_add_u32 s65, s67, 40960
    buffer_load_dwordx4 v3, s[28:31], s65 offen nt lds
    v_mfma_f32_32x32x16_bf16 a[48:63], a[84:87], v[112:115], a[48:63]
    s_add_u32 m0, s64, 11264
    s_add_u32 s65, s67, 45056
    buffer_load_dwordx4 v3, s[28:31], s65 offen nt lds
    s_waitcnt vmcnt(12)
    ds_read_b64_tr_b16 a[64:65], v12 offset:12288
    ds_read_b64_tr_b16 a[66:67], v12 offset:13312
    ds_read_b64_tr_b16 a[68:69], v13 offset:12288
    ds_read_b64_tr_b16 a[70:71], v13 offset:13312
    ds_read_b64_tr_b16 a[72:73], v12 offset:14336
    ds_read_b64_tr_b16 a[74:75], v12 offset:15360
    ds_read_b64_tr_b16 a[76:77], v13 offset:14336
    ds_read_b64_tr_b16 a[78:79], v13 offset:15360
    v_mfma_f32_32x32x16_bf16 a[0:15], a[88:91], v[100:103], a[0:15]
    v_mfma_f32_32x32x16_bf16 a[16:31], a[88:91], v[116:119], a[16:31]
    v_mfma_f32_32x32x16_bf16 a[32:47], a[92:95], v[100:103], a[32:47]
    v_mfma_f32_32x32x16_bf16 a[48:63], a[92:95], v[116:119], a[48:63]
    v_pk_fma_f32 v[128:129], v[128:129], s[84:85], v[26:27] op_sel:[0,0,0] op_sel_hi:[1,1,0] neg_lo:[0,0,1] neg_hi:[0,0,1]
    v_pk_fma_f32 v[130:131], v[130:131], s[84:85], v[26:27] op_sel:[0,0,0] op_sel_hi:[1,1,0] neg_lo:[0,0,1] neg_hi:[0,0,1]
    v_pk_fma_f32 v[132:133], v[132:133], s[84:85], v[26:27] op_sel:[0,0,0] op_sel_hi:[1,1,0] neg_lo:[0,0,1] neg_hi:[0,0,1]
    v_pk_fma_f32 v[134:135], v[134:135], s[84:85], v[26:27] op_sel:[0,0,0] op_sel_hi:[1,1,0] neg_lo:[0,0,1] neg_hi:[0,0,1]
    v_pk_fma_f32 v[136:137], v[136:137], s[84:85], v[26:27] op_sel:[0,0,0] op_sel_hi:[1,1,0] neg_lo:[0,0,1] neg_hi:[0,0,1]
    v_pk_fma_f32 v[138:139], v[138:139], s[84:85], v[26:27] op_sel:[0,0,0] op_sel_hi:[1,1,0] neg_lo:[0,0,1] neg_hi:[0,0,1]
    v_pk_fma_f32 v[140:141], v[140:141], s[84:85], v[26:27] op_sel:[0,0,0] op_sel_hi:[1,1,0] neg_lo:[0,0,1] neg_hi:[0,0,1]
    v_pk_fma_f32 v[142:143], v[142:143], s[84:85], v[26:27] op_sel:[0,0,0] op_sel_hi:[1,1,0] neg_lo:[0,0,1] neg_hi:[0,0,1]
    v_exp_f32 v128, v128
    v_exp_f32 v129, v129
    v_exp_f32 v130, v130
    v_exp_f32 v131, v131
    v_exp_f32 v132, v132
    v_exp_f32 v133, v133
    v_exp_f32 v134, v134
    v_exp_f32 v135, v135
    v_exp_f32 v136, v136
    v_exp_f32 v137, v137
    v_exp_f32 v138, v138
    v_exp_f32 v139, v139
    v_exp_f32 v140, v140
    v_exp_f32 v141, v141
    v_exp_f32 v142, v142
    v_exp_f32 v143, v143
    v_pk_add_f32 v[30:31], v[128:129], v[130:131]
    v_pk_add_f32 v[22:23], v[132:133], v[134:135]
    v_pk_add_f32 v[30:31], v[30:31], v[136:137]
    v_pk_add_f32 v[22:23], v[22:23], v[138:139]
    v_pk_add_f32 v[30:31], v[30:31], v[140:141]
    v_pk_add_f32 v[22:23], v[22:23], v[142:143]
    v_cvt_pk_bf16_f32 v128, v128, v129
    v_cvt_pk_bf16_f32 v129, v130, v131
    v_cvt_pk_bf16_f32 v130, v132, v133
    v_cvt_pk_bf16_f32 v131, v134, v135
    v_cvt_pk_bf16_f32 v132, v136, v137
    v_cvt_pk_bf16_f32 v133, v138, v139
    v_cvt_pk_bf16_f32 v134, v140, v141
    v_cvt_pk_bf16_f32 v135, v142, v143
    v_pk_add_f32 v[30:31], v[30:31], v[22:23]
    v_add_f32 v30, v30, v31
    v_add_f32 v21, v21, v30
    v_pk_fma_f32 v[144:145], v[144:145], s[84:85], v[26:27] op_sel:[0,0,1] op_sel_hi:[1,1,1] neg_lo:[0,0,1] neg_hi:[0,0,1]
    v_pk_fma_f32 v[146:147], v[146:147], s[84:85], v[26:27] op_sel:[0,0,1] op_sel_hi:[1,1,1] neg_lo:[0,0,1] neg_hi:[0,0,1]
    v_pk_fma_f32 v[148:149], v[148:149], s[84:85], v[26:27] op_sel:[0,0,1] op_sel_hi:[1,1,1] neg_lo:[0,0,1] neg_hi:[0,0,1]
    v_pk_fma_f32 v[150:151], v[150:151], s[84:85], v[26:27] op_sel:[0,0,1] op_sel_hi:[1,1,1] neg_lo:[0,0,1] neg_hi:[0,0,1]
    v_pk_fma_f32 v[152:153], v[152:153], s[84:85], v[26:27] op_sel:[0,0,1] op_sel_hi:[1,1,1] neg_lo:[0,0,1] neg_hi:[0,0,1]
    v_pk_fma_f32 v[154:155], v[154:155], s[84:85], v[26:27] op_sel:[0,0,1] op_sel_hi:[1,1,1] neg_lo:[0,0,1] neg_hi:[0,0,1]
    v_pk_fma_f32 v[156:157], v[156:157], s[84:85], v[26:27] op_sel:[0,0,1] op_sel_hi:[1,1,1] neg_lo:[0,0,1] neg_hi:[0,0,1]
    v_pk_fma_f32 v[158:159], v[158:159], s[84:85], v[26:27] op_sel:[0,0,1] op_sel_hi:[1,1,1] neg_lo:[0,0,1] neg_hi:[0,0,1]
    v_exp_f32 v144, v144
    v_exp_f32 v145, v145
    v_exp_f32 v146, v146
    v_exp_f32 v147, v147
    v_exp_f32 v148, v148
    v_exp_f32 v149, v149
    v_exp_f32 v150, v150
    v_exp_f32 v151, v151
    v_exp_f32 v152, v152
    v_exp_f32 v153, v153
    v_exp_f32 v154, v154
    v_exp_f32 v155, v155
    v_exp_f32 v156, v156
    v_exp_f32 v157, v157
    v_exp_f32 v158, v158
    v_exp_f32 v159, v159
    v_pk_add_f32 v[30:31], v[144:145], v[146:147]
    v_pk_add_f32 v[22:23], v[148:149], v[150:151]
    v_pk_add_f32 v[30:31], v[30:31], v[152:153]
    v_pk_add_f32 v[22:23], v[22:23], v[154:155]
    v_pk_add_f32 v[30:31], v[30:31], v[156:157]
    v_pk_add_f32 v[22:23], v[22:23], v[158:159]
    v_cvt_pk_bf16_f32 v144, v144, v145
    v_cvt_pk_bf16_f32 v145, v146, v147
    v_cvt_pk_bf16_f32 v146, v148, v149
    v_cvt_pk_bf16_f32 v147, v150, v151
    v_cvt_pk_bf16_f32 v148, v152, v153
    v_cvt_pk_bf16_f32 v149, v154, v155
    v_cvt_pk_bf16_f32 v150, v156, v157
    v_cvt_pk_bf16_f32 v151, v158, v159
    v_pk_add_f32 v[30:31], v[30:31], v[22:23]
    v_add_f32 v30, v30, v31
    v_add_f32 v29, v29, v30
    s_waitcnt lgkmcnt(0)
    v_mov_b32 v30, v21
    s_nop 1
    v_permlane32_swap_b32 v30, v21
    s_nop 1
    v_add_f32 v21, v21, v30
    v_mov_b32 v30, v29
    s_nop 1
    v_permlane32_swap_b32 v30, v29
    s_nop 1
    v_add_f32 v29, v29, v30
    s_mov_b32 s82, 1048576
L_lw_s0:
    ds_read_b32 v30, v16 offset:8
    s_waitcnt lgkmcnt(0)
    v_readfirstlane_b32 s83, v30
    s_sub_u32 s82, s82, 1
    s_cmp_eq_u32 s82, 0
    s_cbranch_scc1 L_lwd_s0
    s_cmp_ge_u32 s83, 4
    s_cbranch_scc1 L_lwd_s0
    s_sleep 1
    s_branch L_lw_s0
L_lwd_s0:
    ds_write_b64 v18, v[20:21]
    ds_write_b64 v18, v[28:29] offset:512
    v_mfma_f32_32x32x16_bf16 a[0:15], a[64:67], v[128:131], a[0:15]
    s_add_u32 m0, s64, 12288
    s_add_u32 s65, s67, 49152
    buffer_load_dwordx4 v3, s[28:31], s65 offen nt lds
    v_mfma_f32_32x32x16_bf16 a[0:15], a[72:75], v[132:135], a[0:15]
    s_add_u32 m0, s64, 13312
    s_add_u32 s65, s67, 53248
    buffer_load_dwordx4 v3, s[28:31], s65 offen nt lds
    v_mfma_f32_32x32x16_bf16 a[16:31], a[64:67], v[144:147], a[16:31]
    s_add_u32 m0, s64, 14336
    s_add_u32 s65, s67, 57344
    buffer_load_dwordx4 v3, s[28:31], s65 offen nt lds
    v_mfma_f32_32x32x16_bf16 a[16:31], a[72:75], v[148:151], a[16:31]
    s_add_u32 m0, s64, 15360
    s_add_u32 s65, s67, 61440
    buffer_load_dwordx4 v3, s[28:31], s65 offen nt lds
    v_add_u32 v14, s67, v15
    ds_read_b64_tr_b16 a[80:81], v14 offset:0
    ds_read_b64_tr_b16 a[82:83], v14 offset:0
    ds_read_b64_tr_b16 a[84:85], v14 offset:64
    ds_read_b64_tr_b16 a[86:87], v14 offset:64
    s_nop 7
    v_mfma_f32_32x32x16_bf16 a[32:47], a[68:71], v[128:131], a[32:47]
    v_mfma_f32_32x32x16_bf16 a[32:47], a[76:79], v[132:135], a[32:47]
    ds_write_b128 v17, a[0:3] offset:0
    ds_write_b128 v17, a[4:7] offset:1024
    ds_write_b128 v17, a[8:11] offset:2048
    ds_write_b128 v17, a[12:15] offset:3072
    v_mfma_f32_32x32x16_bf16 a[48:63], a[68:71], v[144:147], a[48:63]
    v_mfma_f32_32x32x16_bf16 a[48:63], a[76:79], v[148:151], a[48:63]
    ds_write_b128 v17, a[16:19] offset:4096
    ds_write_b128 v17, a[20:23] offset:5120
    ds_write_b128 v17, a[24:27] offset:6144
    ds_write_b128 v17, a[28:31] offset:7168
    s_nop 3
    ds_write_b128 v17, a[32:35] offset:8192
    ds_write_b128 v17, a[36:39] offset:9216
    ds_write_b128 v17, a[40:43] offset:10240
    ds_write_b128 v17, a[44:47] offset:11264
    s_nop 3
    ds_write_b128 v17, a[48:51] offset:12288
    ds_write_b128 v17, a[52:55] offset:13312
    ds_write_b128 v17, a[56:59] offset:14336
    ds_write_b128 v17, a[60:63] offset:15360
    s_mov_b64 exec, 1
    ds_add_u32 v16, v19 offset:0
    s_mov_b64 exec, -1
    s_waitcnt lgkmcnt(0)
    s_waitcnt vmcnt(12)
    ds_read_b64_tr_b16 a[64:65], v12 offset:0
    ds_read_b64_tr_b16 a[66:67], v12 offset:1024
    ds_read_b64_tr_b16 a[68:69], v13 offset:0
    ds_read_b64_tr_b16 a[70:71], v13 offset:1024
    ds_read_b64_tr_b16 a[72:73], v12 offset:2048
    ds_read_b64_tr_b16 a[74:75], v12 offset:3072
    ds_read_b64_tr_b16 a[76:77], v13 offset:2048
    ds_read_b64_tr_b16 a[78:79], v13 offset:3072
    v_mfma_f32_32x32x16_bf16 a[0:15], a[80:83], v[4:7], 0
    v_mfma_f32_32x32x16_bf16 a[16:31], a[80:83], v[8:11], 0
    v_mfma_f32_32x32x16_bf16 a[32:47], a[84:87], v[4:7], 0
    v_mfma_f32_32x32x16_bf16 a[48:63], a[84:87], v[8:11], 0
    s_waitcnt lgkmcnt(0)
    v_mfma_f32_32x32x16_bf16 a[0:15], a[64:67], v[32:35], a[0:15]
    s_add_u32 m0, s64, 0
    s_add_u32 s65, s68, 0
    buffer_load_dwordx4 v3, s[28:31], s65 offen nt lds
    v_mfma_f32_32x32x16_bf16 a[16:31], a[64:67], v[48:51], a[16:31]
    s_add_u32 m0, s64, 1024
    s_add_u32 s65, s68, 4096
    buffer_load_dwordx4 v3, s[28:31], s65 offen nt lds
    v_mfma_f32_32x32x16_bf16 a[32:47], a[68:71], v[32:35], a[32:47]
    s_add_u32 m0, s64, 2048
    s_add_u32 s65, s68, 8192
    buffer_load_dwordx4 v3, s[28:31], s65 offen nt lds
    v_mfma_f32_32x32x16_bf16 a[48:63], a[68:71], v[48:51], a[48:63]
    s_add_u32 m0, s64, 3072
    s_add_u32 s65, s68, 12288
    buffer_load_dwordx4 v3, s[28:31], s65 offen nt lds
    s_waitcnt vmcnt(12)
    ds_read_b64_tr_b16 a[80:81], v12 offset:4096
    ds_read_b64_tr_b16 a[82:83], v12 offset:5120
    ds_read_b64_tr_b16 a[84:85], v13 offset:4096
    ds_read_b64_tr_b16 a[86:87], v13 offset:5120
    ds_read_b64_tr_b16 a[88:89], v12 offset:6144
    ds_read_b64_tr_b16 a[90:91], v12 offset:7168
    ds_read_b64_tr_b16 a[92:93], v13 offset:6144
    ds_read_b64_tr_b16 a[94:95], v13 offset:7168
    v_mfma_f32_32x32x16_bf16 a[0:15], a[72:75], v[36:39], a[0:15]
    v_mfma_f32_32x32x16_bf16 a[16:31], a[72:75], v[52:55], a[16:31]
    v_mfma_f32_32x32x16_bf16 a[32:47], a[76:79], v[36:39], a[32:47]
    v_mfma_f32_32x32x16_bf16 a[48:63], a[76:79], v[52:55], a[48:63]
    s_waitcnt lgkmcnt(0)
    v_mfma_f32_32x32x16_bf16 a[0:15], a[80:83], v[64:67], a[0:15]
    s_add_u32 m0, s64, 4096
    s_add_u32 s65, s68, 16384
    buffer_load_dwordx4 v3, s[28:31], s65 offen nt lds
    v_mfma_f32_32x32x16_bf16 a[16:31], a[80:83], v[80:83], a[16:31]
    s_add_u32 m0, s64, 5120
    s_add_u32 s65, s68, 20480
    buffer_load_dwordx4 v3, s[28:31], s65 offen nt lds
    v_mfma_f32_32x32x16_bf16 a[32:47], a[84:87], v[64:67], a[32:47]
    s_add_u32 m0, s64, 6144
    s_add_u32 s65, s68, 24576
    buffer_load_dwordx4 v3, s[28:31], s65 offen nt lds
    v_mfma_f32_32x32x16_bf16 a[48:63], a[84:87], v[80:83], a[48:63]
    s_add_u32 m0, s64, 7168
    s_add_u32 s65, s68, 28672
    buffer_load_dwordx4 v3, s[28:31], s65 offen nt lds
    s_waitcnt vmcnt(12)
    ds_read_b64_tr_b16 a[64:65], v12 offset:8192
    ds_read_b64_tr_b16 a[66:67], v12 offset:9216
    ds_read_b64_tr_b16 a[68:69], v13 offset:8192
    ds_read_b64_tr_b16 a[70:71], v13 offset:9216
    ds_read_b64_tr_b16 a[72:73], v12 offset:10240
    ds_read_b64_tr_b16 a[74:75], v12 offset:11264
    ds_read_b64_tr_b16 a[76:77], v13 offset:10240
    ds_read_b64_tr_b16 a[78:79], v13 offset:11264
    v_mfma_f32_32x32x16_bf16 a[0:15], a[88:91], v[68:71], a[0:15]
    v_mfma_f32_32x32x16_bf16 a[16:31], a[88:91], v[84:87], a[16:31]
    v_mfma_f32_32x32x16_bf16 a[32:47], a[92:95], v[68:71], a[32:47]
    v_mfma_f32_32x32x16_bf16 a[48:63], a[92:95], v[84:87], a[48:63]
    s_waitcnt lgkmcnt(0)
    v_mfma_f32_32x32x16_bf16 a[0:15], a[64:67], v[96:99], a[0:15]
    s_add_u32 m0, s64, 8192
    s_add_u32 s65, s68, 32768
    buffer_load_dwordx4 v3, s[28:31], s65 offen nt lds
    v_mfma_f32_32x32x16_bf16 a[16:31], a[64:67], v[112:115], a[16:31]
    s_add_u32 m0, s64, 9216
    s_add_u32 s65, s68, 36864
    buffer_load_dwordx4 v3, s[28:31], s65 offen nt lds
    v_mfma_f32_32x32x16_bf16 a[32:47], a[68:71], v[96:99], a[32:47]
    s_add_u32 m0, s64, 10240
    s_add_u32 s65, s68, 40960
    buffer_load_dwordx4 v3, s[28:31], s65 offen nt lds
    v_mfma_f32_32x32x16_bf16 a[48:63], a[68:71], v[112:115], a[48:63]
    s_add_u32 m0, s64, 11264
    s_add_u32 s65, s68, 45056
    buffer_load_dwordx4 v3, s[28:31], s65 offen nt lds
    s_waitcnt vmcnt(12)
    ds_read_b64_tr_b16 a[80:81], v12 offset:12288
    ds_read_b64_tr_b16 a[82:83], v12 offset:13312
    ds_read_b64_tr_b16 a[84:85], v13 offset:12288
    ds_read_b64_tr_b16 a[86:87], v13 offset:13312
    ds_read_b64_tr_b16 a[88:89], v12 offset:14336
    ds_read_b64_tr_b16 a[90:91], v12 offset:15360
    ds_read_b64_tr_b16 a[92:93], v13 offset:14336
    ds_read_b64_tr_b16 a[94:95], v13 offset:15360
    v_mfma_f32_32x32x16_bf16 a[0:15], a[72:75], v[100:103], a[0:15]
    v_mfma_f32_32x32x16_bf16 a[16:31], a[72:75], v[116:119], a[16:31]
    v_mfma_f32_32x32x16_bf16 a[32:47], a[76:79], v[100:103], a[32:47]
    v_mfma_f32_32x32x16_bf16 a[48:63], a[76:79], v[116:119], a[48:63]
    s_waitcnt lgkmcnt(0)
    s_mov_b32 s82, 1048576
L_lw_s1:
    ds_read_b32 v30, v16 offset:4
    s_waitcnt lgkmcnt(0)
    v_readfirstlane_b32 s83, v30
    s_sub_u32 s82, s82, 1
    s_cmp_eq_u32 s82, 0
    s_cbranch_scc1 L_lwd_s1
    s_cmp_ge_u32 s83, 4
    s_cbranch_scc1 L_lwd_s1
    s_sleep 1
    s_branch L_lw_s1
L_lwd_s1:
    v_mfma_f32_32x32x16_bf16 a[0:15], a[80:83], v[128:131], a[0:15]
    s_add_u32 m0, s64, 12288
    s_add_u32 s65, s68, 49152
    buffer_load_dwordx4 v3, s[28:31], s65 offen nt lds
    v_mfma_f32_32x32x16_bf16 a[0:15], a[88:91], v[132:135], a[0:15]
    s_add_u32 m0, s64, 13312
    s_add_u32 s65, s68, 53248
    buffer_load_dwordx4 v3, s[28:31], s65 offen nt lds
    v_mfma_f32_32x32x16_bf16 a[16:31], a[80:83], v[144:147], a[16:31]
    s_add_u32 m0, s64, 14336
    s_add_u32 s65, s68, 57344
    buffer_load_dwordx4 v3, s[28:31], s65 offen nt lds
    v_mfma_f32_32x32x16_bf16 a[16:31], a[88:91], v[148:151], a[16:31]
    s_add_u32 m0, s64, 15360
    s_add_u32 s65, s68, 61440
    buffer_load_dwordx4 v3, s[28:31], s65 offen nt lds
    v_add_u32 v14, s68, v15
    ds_read_b64_tr_b16 a[64:65], v14 offset:0
    ds_read_b64_tr_b16 a[66:67], v14 offset:0
    ds_read_b64_tr_b16 a[68:69], v14 offset:64
    ds_read_b64_tr_b16 a[70:71], v14 offset:64
    s_nop 7
    v_mfma_f32_32x32x16_bf16 a[32:47], a[84:87], v[128:131], a[32:47]
    v_mfma_f32_32x32x16_bf16 a[32:47], a[92:95], v[132:135], a[32:47]
    ds_write_b128 v17, a[0:3] offset:0
    ds_write_b128 v17, a[4:7] offset:1024
    ds_write_b128 v17, a[8:11] offset:2048
    ds_write_b128 v17, a[12:15] offset:3072
    v_mfma_f32_32x32x16_bf16 a[48:63], a[84:87], v[144:147], a[48:63]
    v_mfma_f32_32x32x16_bf16 a[48:63], a[92:95], v[148:151], a[48:63]
    ds_write_b128 v17, a[16:19] offset:4096
    ds_write_b128 v17, a[20:23] offset:5120
    ds_write_b128 v17, a[24:27] offset:6144
    ds_write_b128 v17, a[28:31] offset:7168
    s_nop 3
    ds_write_b128 v17, a[32:35] offset:8192
    ds_write_b128 v17, a[36:39] offset:9216
    ds_write_b128 v17, a[40:43] offset:10240
    ds_write_b128 v17, a[44:47] offset:11264
    s_nop 3
    ds_write_b128 v17, a[48:51] offset:12288
    ds_write_b128 v17, a[52:55] offset:13312
    ds_write_b128 v17, a[56:59] offset:14336
    ds_write_b128 v17, a[60:63] offset:15360
    s_mov_b64 exec, 1
    ds_add_u32 v16, v19 offset:0
    s_mov_b64 exec, -1
    s_waitcnt lgkmcnt(0)
    s_waitcnt vmcnt(12)
    ds_read_b64_tr_b16 a[80:81], v12 offset:0
    ds_read_b64_tr_b16 a[82:83], v12 offset:1024
    ds_read_b64_tr_b16 a[84:85], v13 offset:0
    ds_read_b64_tr_b16 a[86:87], v13 offset:1024
    ds_read_b64_tr_b16 a[88:89], v12 offset:2048
    ds_read_b64_tr_b16 a[90:91], v12 offset:3072
    ds_read_b64_tr_b16 a[92:93], v13 offset:2048
    ds_read_b64_tr_b16 a[94:95], v13 offset:3072
    v_mfma_f32_32x32x16_bf16 a[0:15], a[64:67], v[4:7], 0
    v_mfma_f32_32x32x16_bf16 a[16:31], a[64:67], v[8:11], 0
    v_mfma_f32_32x32x16_bf16 a[32:47], a[68:71], v[4:7], 0
    v_mfma_f32_32x32x16_bf16 a[48:63], a[68:71], v[8:11], 0
    s_waitcnt lgkmcnt(0)
    v_mfma_f32_32x32x16_bf16 a[0:15], a[80:83], v[32:35], a[0:15]
    s_add_u32 m0, s64, 0
    s_add_u32 s65, s69, 0
    buffer_load_dwordx4 v3, s[28:31], s65 offen nt lds
    v_mfma_f32_32x32x16_bf16 a[16:31], a[80:83], v[48:51], a[16:31]
    s_add_u32 m0, s64, 1024
    s_add_u32 s65, s69, 4096
    buffer_load_dwordx4 v3, s[28:31], s65 offen nt lds
    v_mfma_f32_32x32x16_bf16 a[32:47], a[84:87], v[32:35], a[32:47]
    s_add_u32 m0, s64, 2048
    s_add_u32 s65, s69, 8192
    buffer_load_dwordx4 v3, s[28:31], s65 offen nt lds
    v_mfma_f32_32x32x16_bf16 a[48:63], a[84:87], v[48:51], a[48:63]
    s_add_u32 m0, s64, 3072
    s_add_u32 s65, s69, 12288
    buffer_load_dwordx4 v3, s[28:31], s65 offen nt lds
    s_waitcnt vmcnt(12)
    ds_read_b64_tr_b16 a[64:65], v12 offset:4096
    ds_read_b64_tr_b16 a[66:67], v12 offset:5120
    ds_read_b64_tr_b16 a[68:69], v13 offset:4096
    ds_read_b64_tr_b16 a[70:71], v13 offset:5120
    ds_read_b64_tr_b16 a[72:73], v12 offset:6144
    ds_read_b64_tr_b16 a[74:75], v12 offset:7168
    ds_read_b64_tr_b16 a[76:77], v13 offset:6144
    ds_read_b64_tr_b16 a[78:79], v13 offset:7168
    v_mfma_f32_32x32x16_bf16 a[0:15], a[88:91], v[36:39], a[0:15]
    v_mfma_f32_32x32x16_bf16 a[16:31], a[88:91], v[52:55], a[16:31]
    v_mfma_f32_32x32x16_bf16 a[32:47], a[92:95], v[36:39], a[32:47]
    v_mfma_f32_32x32x16_bf16 a[48:63], a[92:95], v[52:55], a[48:63]
    s_waitcnt lgkmcnt(0)
    v_mfma_f32_32x32x16_bf16 a[0:15], a[64:67], v[64:67], a[0:15]
    s_add_u32 m0, s64, 4096
    s_add_u32 s65, s69, 16384
    buffer_load_dwordx4 v3, s[28:31], s65 offen nt lds
    v_mfma_f32_32x32x16_bf16 a[16:31], a[64:67], v[80:83], a[16:31]
    s_add_u32 m0, s64, 5120
    s_add_u32 s65, s69, 20480
    buffer_load_dwordx4 v3, s[28:31], s65 offen nt lds
    v_mfma_f32_32x32x16_bf16 a[32:47], a[68:71], v[64:67], a[32:47]
    s_add_u32 m0, s64, 6144
    s_add_u32 s65, s69, 24576
    buffer_load_dwordx4 v3, s[28:31], s65 offen nt lds
    v_mfma_f32_32x32x16_bf16 a[48:63], a[68:71], v[80:83], a[48:63]
    s_add_u32 m0, s64, 7168
    s_add_u32 s65, s69, 28672
    buffer_load_dwordx4 v3, s[28:31], s65 offen nt lds
    s_waitcnt vmcnt(12)
    ds_read_b64_tr_b16 a[80:81], v12 offset:8192
    ds_read_b64_tr_b16 a[82:83], v12 offset:9216
    ds_read_b64_tr_b16 a[84:85], v13 offset:8192
    ds_read_b64_tr_b16 a[86:87], v13 offset:9216
    ds_read_b64_tr_b16 a[88:89], v12 offset:10240
    ds_read_b64_tr_b16 a[90:91], v12 offset:11264
    ds_read_b64_tr_b16 a[92:93], v13 offset:10240
    ds_read_b64_tr_b16 a[94:95], v13 offset:11264
    v_mfma_f32_32x32x16_bf16 a[0:15], a[72:75], v[68:71], a[0:15]
    v_mfma_f32_32x32x16_bf16 a[16:31], a[72:75], v[84:87], a[16:31]
    v_mfma_f32_32x32x16_bf16 a[32:47], a[76:79], v[68:71], a[32:47]
    v_mfma_f32_32x32x16_bf16 a[48:63], a[76:79], v[84:87], a[48:63]
    s_waitcnt lgkmcnt(0)
    v_mfma_f32_32x32x16_bf16 a[0:15], a[80:83], v[96:99], a[0:15]
    s_add_u32 m0, s64, 8192
    s_add_u32 s65, s69, 32768
    buffer_load_dwordx4 v3, s[28:31], s65 offen nt lds
    v_mfma_f32_32x32x16_bf16 a[16:31], a[80:83], v[112:115], a[16:31]
    s_add_u32 m0, s64, 9216
    s_add_u32 s65, s69, 36864
    buffer_load_dwordx4 v3, s[28:31], s65 offen nt lds
    v_mfma_f32_32x32x16_bf16 a[32:47], a[84:87], v[96:99], a[32:47]
    s_add_u32 m0, s64, 10240
    s_add_u32 s65, s69, 40960
    buffer_load_dwordx4 v3, s[28:31], s65 offen nt lds
    v_mfma_f32_32x32x16_bf16 a[48:63], a[84:87], v[112:115], a[48:63]
    s_add_u32 m0, s64, 11264
    s_add_u32 s65, s69, 45056
    buffer_load_dwordx4 v3, s[28:31], s65 offen nt lds
    s_waitcnt vmcnt(12)
    ds_read_b64_tr_b16 a[64:65], v12 offset:12288
    ds_read_b64_tr_b16 a[66:67], v12 offset:13312
    ds_read_b64_tr_b16 a[68:69], v13 offset:12288
    ds_read_b64_tr_b16 a[70:71], v13 offset:13312
    ds_read_b64_tr_b16 a[72:73], v12 offset:14336
    ds_read_b64_tr_b16 a[74:75], v12 offset:15360
    ds_read_b64_tr_b16 a[76:77], v13 offset:14336
    ds_read_b64_tr_b16 a[78:79], v13 offset:15360
    v_mfma_f32_32x32x16_bf16 a[0:15], a[88:91], v[100:103], a[0:15]
    v_mfma_f32_32x32x16_bf16 a[16:31], a[88:91], v[116:119], a[16:31]
    v_mfma_f32_32x32x16_bf16 a[32:47], a[92:95], v[100:103], a[32:47]
    v_mfma_f32_32x32x16_bf16 a[48:63], a[92:95], v[116:119], a[48:63]
    s_waitcnt lgkmcnt(0)
    s_mov_b32 s82, 1048576
L_lw_s2:
    ds_read_b32 v30, v16 offset:4
    s_waitcnt lgkmcnt(0)
    v_readfirstlane_b32 s83, v30
    s_sub_u32 s82, s82, 1
    s_cmp_eq_u32 s82, 0
    s_cbranch_scc1 L_lwd_s2
    s_cmp_ge_u32 s83, 8
    s_cbranch_scc1 L_lwd_s2
    s_sleep 1
    s_branch L_lw_s2
L_lwd_s2:
    v_mfma_f32_32x32x16_bf16 a[0:15], a[64:67], v[128:131], a[0:15]
    s_add_u32 m0, s64, 12288
    s_add_u32 s65, s69, 49152
    buffer_load_dwordx4 v3, s[28:31], s65 offen nt lds
    v_mfma_f32_32x32x16_bf16 a[0:15], a[72:75], v[132:135], a[0:15]
    s_add_u32 m0, s64, 13312
    s_add_u32 s65, s69, 53248
    buffer_load_dwordx4 v3, s[28:31], s65 offen nt lds
    v_mfma_f32_32x32x16_bf16 a[16:31], a[64:67], v[144:147], a[16:31]
    s_add_u32 m0, s64, 14336
    s_add_u32 s65, s69, 57344
    buffer_load_dwordx4 v3, s[28:31], s65 offen nt lds
    v_mfma_f32_32x32x16_bf16 a[16:31], a[72:75], v[148:151], a[16:31]
    s_add_u32 m0, s64, 15360
    s_add_u32 s65, s69, 61440
    buffer_load_dwordx4 v3, s[28:31], s65 offen nt lds
    v_add_u32 v14, s69, v15
    ds_read_b64_tr_b16 a[80:81], v14 offset:0
    ds_read_b64_tr_b16 a[82:83], v14 offset:0
    ds_read_b64_tr_b16 a[84:85], v14 offset:64
    ds_read_b64_tr_b16 a[86:87], v14 offset:64
    s_nop 7
    v_mfma_f32_32x32x16_bf16 a[32:47], a[68:71], v[128:131], a[32:47]
    v_mfma_f32_32x32x16_bf16 a[32:47], a[76:79], v[132:135], a[32:47]
    ds_write_b128 v17, a[0:3] offset:0
    ds_write_b128 v17, a[4:7] offset:1024
    ds_write_b128 v17, a[8:11] offset:2048
    ds_write_b128 v17, a[12:15] offset:3072
    v_mfma_f32_32x32x16_bf16 a[48:63], a[68:71], v[144:147], a[48:63]
    v_mfma_f32_32x32x16_bf16 a[48:63], a[76:79], v[148:151], a[48:63]
    ds_write_b128 v17, a[16:19] offset:4096
    ds_write_b128 v17, a[20:23] offset:5120
    ds_write_b128 v17, a[24:27] offset:6144
    ds_write_b128 v17, a[28:31] offset:7168
    s_nop 3
    ds_write_b128 v17, a[32:35] offset:8192
    ds_write_b128 v17, a[36:39] offset:9216
    ds_write_b128 v17, a[40:43] offset:10240
    ds_write_b128 v17, a[44:47] offset:11264
    s_nop 3
    ds_write_b128 v17, a[48:51] offset:12288
    ds_write_b128 v17, a[52:55] offset:13312
    ds_write_b128 v17, a[56:59] offset:14336
    ds_write_b128 v17, a[60:63] offset:15360
    s_mov_b64 exec, 1
    ds_add_u32 v16, v19 offset:0
    s_mov_b64 exec, -1
    s_waitcnt lgkmcnt(0)
    s_waitcnt vmcnt(12)
    ds_read_b64_tr_b16 a[64:65], v12 offset:0
    ds_read_b64_tr_b16 a[66:67], v12 offset:1024
    ds_read_b64_tr_b16 a[68:69], v13 offset:0
    ds_read_b64_tr_b16 a[70:71], v13 offset:1024
    ds_read_b64_tr_b16 a[72:73], v12 offset:2048
    ds_read_b64_tr_b16 a[74:75], v12 offset:3072
    ds_read_b64_tr_b16 a[76:77], v13 offset:2048
    ds_read_b64_tr_b16 a[78:79], v13 offset:3072
    v_mfma_f32_32x32x16_bf16 a[0:15], a[80:83], v[4:7], 0
    v_mfma_f32_32x32x16_bf16 a[16:31], a[80:83], v[8:11], 0
    v_mfma_f32_32x32x16_bf16 a[32:47], a[84:87], v[4:7], 0
    v_mfma_f32_32x32x16_bf16 a[48:63], a[84:87], v[8:11], 0
    s_waitcnt lgkmcnt(0)
    v_mfma_f32_32x32x16_bf16 a[0:15], a[64:67], v[32:35], a[0:15]
    v_mfma_f32_32x32x16_bf16 a[16:31], a[64:67], v[48:51], a[16:31]
    v_mfma_f32_32x32x16_bf16 a[32:47], a[68:71], v[32:35], a[32:47]
    v_mfma_f32_32x32x16_bf16 a[48:63], a[68:71], v[48:51], a[48:63]
    s_waitcnt vmcnt(8)
    ds_read_b64_tr_b16 a[80:81], v12 offset:4096
    ds_read_b64_tr_b16 a[82:83], v12 offset:5120
    ds_read_b64_tr_b16 a[84:85], v13 offset:4096
    ds_read_b64_tr_b16 a[86:87], v13 offset:5120
    ds_read_b64_tr_b16 a[88:89], v12 offset:6144
    ds_read_b64_tr_b16 a[90:91], v12 offset:7168
    ds_read_b64_tr_b16 a[92:93], v13 offset:6144
    ds_read_b64_tr_b16 a[94:95], v13 offset:7168
    v_mfma_f32_32x32x16_bf16 a[0:15], a[72:75], v[36:39], a[0:15]
    v_mfma_f32_32x32x16_bf16 a[16:31], a[72:75], v[52:55], a[16:31]
    v_mfma_f32_32x32x16_bf16 a[32:47], a[76:79], v[36:39], a[32:47]
    v_mfma_f32_32x32x16_bf16 a[48:63], a[76:79], v[52:55], a[48:63]
    s_waitcnt lgkmcnt(0)
    v_mfma_f32_32x32x16_bf16 a[0:15], a[80:83], v[64:67], a[0:15]
    v_mfma_f32_32x32x16_bf16 a[16:31], a[80:83], v[80:83], a[16:31]
    v_mfma_f32_32x32x16_bf16 a[32:47], a[84:87], v[64:67], a[32:47]
    v_mfma_f32_32x32x16_bf16 a[48:63], a[84:87], v[80:83], a[48:63]
    s_waitcnt vmcnt(4)
    ds_read_b64_tr_b16 a[64:65], v12 offset:8192
    ds_read_b64_tr_b16 a[66:67], v12 offset:9216
    ds_read_b64_tr_b16 a[68:69], v13 offset:8192
    ds_read_b64_tr_b16 a[70:71], v13 offset:9216
    ds_read_b64_tr_b16 a[72:73], v12 offset:10240
    ds_read_b64_tr_b16 a[74:75], v12 offset:11264
    ds_read_b64_tr_b16 a[76:77], v13 offset:10240
    ds_read_b64_tr_b16 a[78:79], v13 offset:11264
    v_mfma_f32_32x32x16_bf16 a[0:15], a[88:91], v[68:71], a[0:15]
    v_mfma_f32_32x32x16_bf16 a[16:31], a[88:91], v[84:87], a[16:31]
    v_mfma_f32_32x32x16_bf16 a[32:47], a[92:95], v[68:71], a[32:47]
    v_mfma_f32_32x32x16_bf16 a[48:63], a[92:95], v[84:87], a[48:63]
    s_waitcnt lgkmcnt(0)
    v_mfma_f32_32x32x16_bf16 a[0:15], a[64:67], v[96:99], a[0:15]
    v_mfma_f32_32x32x16_bf16 a[16:31], a[64:67], v[112:115], a[16:31]
    v_mfma_f32_32x32x16_bf16 a[32:47], a[68:71], v[96:99], a[32:47]
    v_mfma_f32_32x32x16_bf16 a[48:63], a[68:71], v[112:115], a[48:63]
    s_waitcnt vmcnt(0)
    ds_read_b64_tr_b16 a[80:81], v12 offset:12288
    ds_read_b64_tr_b16 a[82:83], v12 offset:13312
    ds_read_b64_tr_b16 a[84:85], v13 offset:12288
    ds_read_b64_tr_b16 a[86:87], v13 offset:13312
    ds_read_b64_tr_b16 a[88:89], v12 offset:14336
    ds_read_b64_tr_b16 a[90:91], v12 offset:15360
    ds_read_b64_tr_b16 a[92:93], v13 offset:14336
    ds_read_b64_tr_b16 a[94:95], v13 offset:15360
    v_mfma_f32_32x32x16_bf16 a[0:15], a[72:75], v[100:103], a[0:15]
    v_mfma_f32_32x32x16_bf16 a[16:31], a[72:75], v[116:119], a[16:31]
    v_mfma_f32_32x32x16_bf16 a[32:47], a[76:79], v[100:103], a[32:47]
    v_mfma_f32_32x32x16_bf16 a[48:63], a[76:79], v[116:119], a[48:63]
    s_waitcnt lgkmcnt(0)
    s_mov_b32 s82, 1048576
L_lw_s3:
    ds_read_b32 v30, v16 offset:4
    s_waitcnt lgkmcnt(0)
    v_readfirstlane_b32 s83, v30
    s_sub_u32 s82, s82, 1
    s_cmp_eq_u32 s82, 0
    s_cbranch_scc1 L_lwd_s3
    s_cmp_ge_u32 s83, 12
    s_cbranch_scc1 L_lwd_s3
    s_sleep 1
    s_branch L_lw_s3
L_lwd_s3:
    v_mfma_f32_32x32x16_bf16 a[0:15], a[80:83], v[128:131], a[0:15]
    v_mfma_f32_32x32x16_bf16 a[0:15], a[88:91], v[132:135], a[0:15]
    v_mfma_f32_32x32x16_bf16 a[16:31], a[80:83], v[144:147], a[16:31]
    v_mfma_f32_32x32x16_bf16 a[16:31], a[88:91], v[148:151], a[16:31]
    s_nop 7
    v_mfma_f32_32x32x16_bf16 a[32:47], a[84:87], v[128:131], a[32:47]
    v_mfma_f32_32x32x16_bf16 a[32:47], a[92:95], v[132:135], a[32:47]
    ds_write_b128 v17, a[0:3] offset:0
    ds_write_b128 v17, a[4:7] offset:1024
    ds_write_b128 v17, a[8:11] offset:2048
    ds_write_b128 v17, a[12:15] offset:3072
    v_mfma_f32_32x32x16_bf16 a[48:63], a[84:87], v[144:147], a[48:63]
    v_mfma_f32_32x32x16_bf16 a[48:63], a[92:95], v[148:151], a[48:63]
    ds_write_b128 v17, a[16:19] offset:4096
    ds_write_b128 v17, a[20:23] offset:5120
    ds_write_b128 v17, a[24:27] offset:6144
    ds_write_b128 v17, a[28:31] offset:7168
    s_nop 3
    ds_write_b128 v17, a[32:35] offset:8192
    ds_write_b128 v17, a[36:39] offset:9216
    ds_write_b128 v17, a[40:43] offset:10240
    ds_write_b128 v17, a[44:47] offset:11264
    s_nop 3
    ds_write_b128 v17, a[48:51] offset:12288
    ds_write_b128 v17, a[52:55] offset:13312
    ds_write_b128 v17, a[56:59] offset:14336
    ds_write_b128 v17, a[60:63] offset:15360
    s_mov_b64 exec, 1
    ds_add_u32 v16, v19 offset:0
    s_mov_b64 exec, -1
    s_waitcnt lgkmcnt(0)
    s_endpgm
L_helper:
    s_setprio 2
    v_lshlrev_b32 v3, 4, v0
    v_lshlrev_b32 v6, 3, v0
    v_mov_b32 v9, 0
    v_mov_b32 v10, 1
    v_mov_b32 v11, 0xffff0000
    v_mov_b32 v24, 139264
    s_lshl_b32 s81, s63, 2
    s_lshl_b32 s78, s3, 2
    s_add_u32 s78, s78, s61
    s_lshl_b32 s79, s78, 7
    s_add_u32 s79, s79, 67108864
    s_mul_i32 s80, s78, 3072
    buffer_load_dword v31, v9, s[56:59], s79 offen sc1
    s_lshr_b32 s74, s66, 7
    s_add_u32 s74, s74, s81
    s_lshl_b32 s74, s74, 2
    s_add_u32 s12, s74, s61
    s_lshr_b32 s74, s67, 7
    s_add_u32 s74, s74, s81
    s_lshl_b32 s74, s74, 2
    s_add_u32 s13, s74, s61
    s_lshr_b32 s74, s68, 7
    s_add_u32 s74, s74, s81
    s_lshl_b32 s74, s74, 2
    s_add_u32 s14, s74, s61
    s_getreg_b32 s21, hwreg(HW_REG_XCC_ID)
    s_and_b32 s21, s21, 15
    s_or_b32 s21, s21, 0x80
    s_and_b32 s74, s61, 1
    s_lshl_b32 s74, s74, 9
    s_add_u32 s74, s74, 135168
    v_add_u32 v7, s74, v6
    s_lshl_b32 s74, s61, 12
    s_add_u32 s74, s74, 65536
    v_add_u32 v8, s74, v3
    v_and_b32 v2, 31, v0
    v_lshlrev_b32 v2, 9, v2
    v_lshrrev_b32 v1, 5, v0
    v_lshl_add_u32 v2, v1, 4, v2
    s_and_b32 s74, s61, 1
    s_lshl_b32 s74, s74, 14
    s_lshr_b32 s75, s61, 1
    s_lshl_b32 s75, s75, 6
    s_add_u32 s74, s74, s75
    s_lshl_b32 s75, s62, 7
    s_add_u32 s84, s74, s75
    s_waitcnt vmcnt(0)
    v_readfirstlane_b32 s19, v31
    s_nop 1
    s_add_u32 s20, s19, 4
    s_add_u32 s19, s19, 1
    s_and_b32 s19, s19, 0xffff
    s_lshl_b32 s74, s19, 8
    s_or_b32 s74, s74, s21
    v_mov_b32 v31, s74
    s_mov_b64 exec, 1
    buffer_store_dword v31, v9, s[56:59], s79 offen offset:4 sc1
    s_mov_b64 exec, -1
    s_mov_b32 s82, 1048576
L_lw_hp1b:
    ds_read_b32 v25, v24 offset:8
    s_waitcnt lgkmcnt(0)
    v_readfirstlane_b32 s83, v25
    s_sub_u32 s82, s82, 1
    s_cmp_eq_u32 s82, 0
    s_cbranch_scc1 L_lwd_hp1b
    s_cmp_ge_u32 s83, 4
    s_cbranch_scc1 L_lwd_hp1b
    s_sleep 8
    s_branch L_lw_hp1b
L_lwd_hp1b:
    s_lshl_b32 s75, s12, 7
    s_add_u32 s75, s75, 67108864
    buffer_load_dwordx2 v[26:27], v9, s[56:59], s75 offen sc1
    s_lshl_b32 s75, s13, 7
    s_add_u32 s75, s75, 67108864
    buffer_load_dwordx2 v[28:29], v9, s[56:59], s75 offen sc1
    s_lshl_b32 s75, s14, 7
    s_add_u32 s75, s75, 67108864
    buffer_load_dwordx2 v[30:31], v9, s[56:59], s75 offen sc1
    s_waitcnt vmcnt(0)
    v_readfirstlane_b32 s16, v26
    v_readfirstlane_b32 s8, v27
    v_readfirstlane_b32 s17, v28
    v_readfirstlane_b32 s9, v29
    v_readfirstlane_b32 s18, v30
    v_readfirstlane_b32 s10, v31
    s_nop 1
    s_add_u32 s16, s16, 1
    s_and_b32 s16, s16, 0xffff
    s_lshl_b32 s74, s16, 8
    s_or_b32 s74, s74, s21
    s_cmp_eq_u32 s74, s8
    s_cselect_b32 s8, 1, 0
    s_add_u32 s17, s17, 1
    s_and_b32 s17, s17, 0xffff
    s_lshl_b32 s74, s17, 8
    s_or_b32 s74, s74, s21
    s_cmp_eq_u32 s74, s9
    s_cselect_b32 s9, 1, 0
    s_add_u32 s18, s18, 1
    s_and_b32 s18, s18, 0xffff
    s_lshl_b32 s74, s18, 8
    s_or_b32 s74, s74, s21
    s_cmp_eq_u32 s74, s10
    s_cselect_b32 s10, 1, 0
    v_cmp_gt_u32 s[22:23], 32, v0
    s_mul_i32 s12, s12, 3072
    s_mul_i32 s13, s13, 3072
    s_mul_i32 s14, s14, 3072
    s_mov_b32 s15, s80
    s_mov_b32 s82, 1048576
L_lw_h0:
    ds_read_b32 v25, v24 offset:0
    s_waitcnt lgkmcnt(0)
    v_readfirstlane_b32 s83, v25
    s_sub_u32 s82, s82, 1
    s_cmp_eq_u32 s82, 0
    s_cbranch_scc1 L_lwd_h0
    s_cmp_ge_u32 s83, 4
    s_cbranch_scc1 L_lwd_h0
    s_sleep 1
    s_branch L_lw_h0
L_lwd_h0:
    ds_read_b64 v[16:17], v7 offset:0
    ds_read_b64 v[18:19], v7 offset:1024
    ds_read_b64 v[20:21], v7 offset:2048
    ds_read_b64 v[22:23], v7 offset:3072
    ds_read_b128 v[32:35], v8 offset:0
    ds_read_b128 v[36:39], v8 offset:1024
    ds_read_b128 v[40:43], v8 offset:2048
    ds_read_b128 v[44:47], v8 offset:3072
    ds_read_b128 v[48:51], v8 offset:16384
    ds_read_b128 v[52:55], v8 offset:17408
    ds_read_b128 v[56:59], v8 offset:18432
    ds_read_b128 v[60:63], v8 offset:19456
    ds_read_b128 v[64:67], v8 offset:32768
    ds_read_b128 v[68:71], v8 offset:33792
    ds_read_b128 v[72:75], v8 offset:34816
    ds_read_b128 v[76:79], v8 offset:35840
    ds_read_b128 v[80:83], v8 offset:49152
    ds_read_b128 v[84:87], v8 offset:50176
    ds_read_b128 v[88:91], v8 offset:51200
    ds_read_b128 v[92:95], v8 offset:52224
    s_waitcnt lgkmcnt(15)
    v_max3_f32 v4, v16, v18, v20
    v_max_f32 v4, v4, v22
    v_sub_f32 v12, v16, v4
    v_sub_f32 v13, v18, v4
    v_sub_f32 v14, v20, v4
    v_sub_f32 v15, v22, v4
    v_mul_f32 v12, s77, v12
    v_mul_f32 v13, s77, v13
    v_mul_f32 v14, s77, v14
    v_mul_f32 v15, s77, v15
    v_exp_f32 v12, v12
    v_exp_f32 v13, v13
    v_exp_f32 v14, v14
    v_exp_f32 v15, v15
    s_nop 0
    v_mul_f32 v5, v12, v17
    v_fma_f32 v5, v13, v19, v5
    v_fma_f32 v5, v14, v21, v5
    v_fma_f32 v5, v15, v23, v5
    v_rcp_f32 v26, v5
    v_cndmask_b32 v1, v5, v4, s[22:23]
    v_mul_f32 v12, v26, v12
    v_mul_f32 v13, v26, v13
    v_mul_f32 v14, v26, v14
    v_mul_f32 v15, v26, v15
    s_waitcnt lgkmcnt(12)
    v_mul_f32 v96, v12, v32
    v_mul_f32 v97, v12, v33
    v_mul_f32 v98, v12, v34
    v_mul_f32 v99, v12, v35
    v_mul_f32 v100, v12, v36
    v_mul_f32 v101, v12, v37
    v_mul_f32 v102, v12, v38
    v_mul_f32 v103, v12, v39
    v_mul_f32 v104, v12, v40
    v_mul_f32 v105, v12, v41
    v_mul_f32 v106, v12, v42
    v_mul_f32 v107, v12, v43
    v_mul_f32 v108, v12, v44
    v_mul_f32 v109, v12, v45
    v_mul_f32 v110, v12, v46
    v_mul_f32 v111, v12, v47
    s_waitcnt lgkmcnt(8)
    v_fma_f32 v96, v13, v48, v96
    v_fma_f32 v97, v13, v49, v97
    v_fma_f32 v98, v13, v50, v98
    v_fma_f32 v99, v13, v51, v99
    v_fma_f32 v100, v13, v52, v100
    v_fma_f32 v101, v13, v53, v101
    v_fma_f32 v102, v13, v54, v102
    v_fma_f32 v103, v13, v55, v103
    v_fma_f32 v104, v13, v56, v104
    v_fma_f32 v105, v13, v57, v105
    v_fma_f32 v106, v13, v58, v106
    v_fma_f32 v107, v13, v59, v107
    v_fma_f32 v108, v13, v60, v108
    v_fma_f32 v109, v13, v61, v109
    v_fma_f32 v110, v13, v62, v110
    v_fma_f32 v111, v13, v63, v111
    s_waitcnt lgkmcnt(4)
    v_fma_f32 v96, v14, v64, v96
    v_fma_f32 v97, v14, v65, v97
    v_fma_f32 v98, v14, v66, v98
    v_fma_f32 v99, v14, v67, v99
    v_fma_f32 v100, v14, v68, v100
    v_fma_f32 v101, v14, v69, v101
    v_fma_f32 v102, v14, v70, v102
    v_fma_f32 v103, v14, v71, v103
    v_fma_f32 v104, v14, v72, v104
    v_fma_f32 v105, v14, v73, v105
    v_fma_f32 v106, v14, v74, v106
    v_fma_f32 v107, v14, v75, v107
    v_fma_f32 v108, v14, v76, v108
    v_fma_f32 v109, v14, v77, v109
    v_fma_f32 v110, v14, v78, v110
    v_fma_f32 v111, v14, v79, v111
    s_waitcnt lgkmcnt(0)
    s_mov_b64 exec, 1
    ds_add_u32 v24, v10 offset:4
    s_mov_b64 exec, -1
    v_fma_f32 v96, v15, v80, v96
    v_fma_f32 v97, v15, v81, v97
    v_fma_f32 v98, v15, v82, v98
    v_fma_f32 v99, v15, v83, v99
    v_fma_f32 v100, v15, v84, v100
    v_fma_f32 v101, v15, v85, v101
    v_fma_f32 v102, v15, v86, v102
    v_fma_f32 v103, v15, v87, v103
    v_fma_f32 v104, v15, v88, v104
    v_fma_f32 v105, v15, v89, v105
    v_fma_f32 v106, v15, v90, v106
    v_fma_f32 v107, v15, v91, v107
    v_fma_f32 v108, v15, v92, v108
    v_fma_f32 v109, v15, v93, v109
    v_fma_f32 v110, v15, v94, v110
    v_fma_f32 v111, v15, v95, v111
    s_add_u32 s74, s16, 0
    s_and_b32 s74, s74, 0xffff
    v_cvt_pk_bf16_f32 v32, v96, v97
    v_cvt_pk_bf16_f32 v34, v98, v99
    v_cvt_pk_bf16_f32 v36, v100, v101
    v_cvt_pk_bf16_f32 v38, v102, v103
    v_cvt_pk_bf16_f32 v40, v104, v105
    v_cvt_pk_bf16_f32 v42, v106, v107
    v_cvt_pk_bf16_f32 v46, v108, v109
    v_cvt_pk_bf16_f32 v47, v110, v111
    v_lshl_or_b32 v33, v46, 16, s74
    v_and_or_b32 v35, v46, v11, s74
    v_lshl_or_b32 v37, v47, 16, s74
    v_and_or_b32 v39, v47, v11, s74
    v_and_or_b32 v41, v1, v11, s74
    v_lshl_or_b32 v43, v1, 16, s74
    s_cmp_eq_u32 s10, 1
    s_cbranch_scc1 L_pub_f0
    buffer_store_dwordx4 v[32:35], v3, s[56:59], s12 offen offset:0 sc1
    buffer_store_dwordx4 v[36:39], v3, s[56:59], s12 offen offset:1024 sc1
    buffer_store_dwordx4 v[40:43], v3, s[56:59], s12 offen offset:2048 sc1
    s_branch L_pub_e0
L_pub_f0:
    buffer_store_dwordx4 v[32:35], v3, s[56:59], s12 offen offset:0
    buffer_store_dwordx4 v[36:39], v3, s[56:59], s12 offen offset:1024
    buffer_store_dwordx4 v[40:43], v3, s[56:59], s12 offen offset:2048
L_pub_e0:
    s_nop 1
    s_mov_b32 s82, 1048576
L_lw_h1:
    ds_read_b32 v25, v24 offset:0
    s_waitcnt lgkmcnt(0)
    v_readfirstlane_b32 s83, v25
    s_sub_u32 s82, s82, 1
    s_cmp_eq_u32 s82, 0
    s_cbranch_scc1 L_lwd_h1
    s_cmp_ge_u32 s83, 8
    s_cbranch_scc1 L_lwd_h1
    s_sleep 1
    s_branch L_lw_h1
L_lwd_h1:
    ds_read_b128 v[32:35], v8 offset:0
    ds_read_b128 v[36:39], v8 offset:1024
    ds_read_b128 v[40:43], v8 offset:2048
    ds_read_b128 v[44:47], v8 offset:3072
    ds_read_b128 v[48:51], v8 offset:16384
    ds_read_b128 v[52:55], v8 offset:17408
    ds_read_b128 v[56:59], v8 offset:18432
    ds_read_b128 v[60:63], v8 offset:19456
    ds_read_b128 v[64:67], v8 offset:32768
    ds_read_b128 v[68:71], v8 offset:33792
    ds_read_b128 v[72:75], v8 offset:34816
    ds_read_b128 v[76:79], v8 offset:35840
    ds_read_b128 v[80:83], v8 offset:49152
    ds_read_b128 v[84:87], v8 offset:50176
    ds_read_b128 v[88:91], v8 offset:51200
    ds_read_b128 v[92:95], v8 offset:52224
    buffer_load_dwordx4 v[112:115], v3, s[56:59], s13 offen offset:0
    buffer_load_dwordx4 v[116:119], v3, s[56:59], s13 offen offset:1024
    buffer_load_dwordx4 v[120:123], v3, s[56:59], s13 offen offset:2048
    s_waitcnt lgkmcnt(12)
    v_mul_f32 v96, v12, v32
    v_mul_f32 v97, v12, v33
    v_mul_f32 v98, v12, v34
    v_mul_f32 v99, v12, v35
    v_mul_f32 v100, v12, v36
    v_mul_f32 v101, v12, v37
    v_mul_f32 v102, v12, v38
    v_mul_f32 v103, v12, v39
    v_mul_f32 v104, v12, v40
    v_mul_f32 v105, v12, v41
    v_mul_f32 v106, v12, v42
    v_mul_f32 v107, v12, v43
    v_mul_f32 v108, v12, v44
    v_mul_f32 v109, v12, v45
    v_mul_f32 v110, v12, v46
    v_mul_f32 v111, v12, v47
    s_waitcnt lgkmcnt(8)
    v_fma_f32 v96, v13, v48, v96
    v_fma_f32 v97, v13, v49, v97
    v_fma_f32 v98, v13, v50, v98
    v_fma_f32 v99, v13, v51, v99
    v_fma_f32 v100, v13, v52, v100
    v_fma_f32 v101, v13, v53, v101
    v_fma_f32 v102, v13, v54, v102
    v_fma_f32 v103, v13, v55, v103
    v_fma_f32 v104, v13, v56, v104
    v_fma_f32 v105, v13, v57, v105
    v_fma_f32 v106, v13, v58, v106
    v_fma_f32 v107, v13, v59, v107
    v_fma_f32 v108, v13, v60, v108
    v_fma_f32 v109, v13, v61, v109
    v_fma_f32 v110, v13, v62, v110
    v_fma_f32 v111, v13, v63, v111
    s_waitcnt lgkmcnt(4)
    v_fma_f32 v96, v14, v64, v96
    v_fma_f32 v97, v14, v65, v97
    v_fma_f32 v98, v14, v66, v98
    v_fma_f32 v99, v14, v67, v99
    v_fma_f32 v100, v14, v68, v100
    v_fma_f32 v101, v14, v69, v101
    v_fma_f32 v102, v14, v70, v102
    v_fma_f32 v103, v14, v71, v103
    v_fma_f32 v104, v14, v72, v104
    v_fma_f32 v105, v14, v73, v105
    v_fma_f32 v106, v14, v74, v106
    v_fma_f32 v107, v14, v75, v107
    v_fma_f32 v108, v14, v76, v108
    v_fma_f32 v109, v14, v77, v109
    v_fma_f32 v110, v14, v78, v110
    v_fma_f32 v111, v14, v79, v111
    s_waitcnt lgkmcnt(0)
    s_mov_b64 exec, 1
    ds_add_u32 v24, v10 offset:4
    s_mov_b64 exec, -1
    v_fma_f32 v96, v15, v80, v96
    v_fma_f32 v97, v15, v81, v97
    v_fma_f32 v98, v15, v82, v98
    v_fma_f32 v99, v15, v83, v99
    v_fma_f32 v100, v15, v84, v100
    v_fma_f32 v101, v15, v85, v101
    v_fma_f32 v102, v15, v86, v102
    v_fma_f32 v103, v15, v87, v103
    v_fma_f32 v104, v15, v88, v104
    v_fma_f32 v105, v15, v89, v105
    v_fma_f32 v106, v15, v90, v106
    v_fma_f32 v107, v15, v91, v107
    v_fma_f32 v108, v15, v92, v108
    v_fma_f32 v109, v15, v93, v109
    v_fma_f32 v110, v15, v94, v110
    v_fma_f32 v111, v15, v95, v111
    s_add_u32 s74, s17, 0
    s_and_b32 s74, s74, 0xffff
    s_mov_b32 s82, 1048576
L_poll_m1:
    s_waitcnt vmcnt(0)
    v_xor_b32 v50, s74, v113
    v_xor_b32 v51, s74, v115
    v_or_b32 v50, v50, v51
    v_xor_b32 v51, s74, v117
    v_or_b32 v50, v50, v51
    v_xor_b32 v51, s74, v119
    v_or_b32 v50, v50, v51
    v_xor_b32 v51, s74, v121
    v_or_b32 v50, v50, v51
    v_xor_b32 v51, s74, v123
    v_or_b32 v50, v50, v51
    v_and_b32 v50, 0xffff, v50
    v_cmp_ne_u32 vcc, 0, v50
    s_sub_u32 s82, s82, 1
    s_cmp_eq_u32 s82, 0
    s_cbranch_scc1 L_polldone_m1
    s_cmp_eq_u64 vcc, 0
    s_cbranch_scc1 L_polldone_m1
    s_sleep 2
    buffer_load_dwordx4 v[112:115], v3, s[56:59], s13 offen offset:0 sc1
    buffer_load_dwordx4 v[116:119], v3, s[56:59], s13 offen offset:1024 sc1
    buffer_load_dwordx4 v[120:123], v3, s[56:59], s13 offen offset:2048 sc1
    s_branch L_poll_m1
L_polldone_m1:
    v_lshrrev_b32 v50, 16, v123
    v_and_or_b32 v52, v121, v11, v50
    v_mov_b32 v53, v52
    s_nop 1
    v_permlane32_swap_b32 v52, v53
    s_nop 1
    v_max_f32 v16, v4, v52
    v_sub_f32 v17, v4, v16
    v_sub_f32 v18, v52, v16
    v_mul_f32 v17, s77, v17
    v_mul_f32 v18, s77, v18
    v_exp_f32 v17, v17
    v_exp_f32 v18, v18
    s_nop 0
    v_mul_f32 v17, v17, v5
    v_mul_f32 v18, v18, v53
    v_add_f32 v19, v17, v18
    v_rcp_f32 v21, v19
    v_cndmask_b32 v1, v19, v16, s[22:23]
    v_mul_f32 v17, v17, v21
    v_mul_f32 v18, v18, v21
    v_mul_f32 v96, v17, v96
    v_mul_f32 v97, v17, v97
    v_mul_f32 v98, v17, v98
    v_mul_f32 v99, v17, v99
    v_mul_f32 v100, v17, v100
    v_mul_f32 v101, v17, v101
    v_mul_f32 v102, v17, v102
    v_mul_f32 v103, v17, v103
    v_mul_f32 v104, v17, v104
    v_mul_f32 v105, v17, v105
    v_mul_f32 v106, v17, v106
    v_mul_f32 v107, v17, v107
    v_mul_f32 v108, v17, v108
    v_mul_f32 v109, v17, v109
    v_mul_f32 v110, v17, v110
    v_mul_f32 v111, v17, v111
    v_lshlrev_b32 v27, 16, v112
    v_and_b32 v28, v11, v112
    v_fma_f32 v96, v18, v27, v96
    v_fma_f32 v97, v18, v28, v97
    v_lshlrev_b32 v27, 16, v114
    v_and_b32 v28, v11, v114
    v_fma_f32 v98, v18, v27, v98
    v_fma_f32 v99, v18, v28, v99
    v_lshlrev_b32 v27, 16, v116
    v_and_b32 v28, v11, v116
    v_fma_f32 v100, v18, v27, v100
    v_fma_f32 v101, v18, v28, v101
    v_lshlrev_b32 v27, 16, v118
    v_and_b32 v28, v11, v118
    v_fma_f32 v102, v18, v27, v102
    v_fma_f32 v103, v18, v28, v103
    v_lshlrev_b32 v27, 16, v120
    v_and_b32 v28, v11, v120
    v_fma_f32 v104, v18, v27, v104
    v_fma_f32 v105, v18, v28, v105
    v_lshlrev_b32 v27, 16, v122
    v_and_b32 v28, v11, v122
    v_fma_f32 v106, v18, v27, v106
    v_fma_f32 v107, v18, v28, v107
    v_and_b32 v27, v11, v113
    v_fma_f32 v108, v18, v27, v108
    v_and_b32 v27, v11, v115
    v_fma_f32 v109, v18, v27, v109
    v_and_b32 v27, v11, v117
    v_fma_f32 v110, v18, v27, v110
    v_and_b32 v27, v11, v119
    v_fma_f32 v111, v18, v27, v111
    s_add_u32 s74, s17, 1
    s_and_b32 s74, s74, 0xffff
    v_cvt_pk_bf16_f32 v32, v96, v97
    v_cvt_pk_bf16_f32 v34, v98, v99
    v_cvt_pk_bf16_f32 v36, v100, v101
    v_cvt_pk_bf16_f32 v38, v102, v103
    v_cvt_pk_bf16_f32 v40, v104, v105
    v_cvt_pk_bf16_f32 v42, v106, v107
    v_cvt_pk_bf16_f32 v46, v108, v109
    v_cvt_pk_bf16_f32 v47, v110, v111
    v_lshl_or_b32 v33, v46, 16, s74
    v_and_or_b32 v35, v46, v11, s74
    v_lshl_or_b32 v37, v47, 16, s74
    v_and_or_b32 v39, v47, v11, s74
    v_and_or_b32 v41, v1, v11, s74
    v_lshl_or_b32 v43, v1, 16, s74
    s_cmp_eq_u32 s10, 1
    s_cbranch_scc1 L_pub_f1
    buffer_store_dwordx4 v[32:35], v3, s[56:59], s13 offen offset:0 sc1
    buffer_store_dwordx4 v[36:39], v3, s[56:59], s13 offen offset:1024 sc1
    buffer_store_dwordx4 v[40:43], v3, s[56:59], s13 offen offset:2048 sc1
    s_branch L_pub_e1
L_pub_f1:
    buffer_store_dwordx4 v[32:35], v3, s[56:59], s13 offen offset:0
    buffer_store_dwordx4 v[36:39], v3, s[56:59], s13 offen offset:1024
    buffer_store_dwordx4 v[40:43], v3, s[56:59], s13 offen offset:2048
L_pub_e1:
    s_nop 1
    s_mov_b32 s82, 1048576
L_lw_h2:
    ds_read_b32 v25, v24 offset:0
    s_waitcnt lgkmcnt(0)
    v_readfirstlane_b32 s83, v25
    s_sub_u32 s82, s82, 1
    s_cmp_eq_u32 s82, 0
    s_cbranch_scc1 L_lwd_h2
    s_cmp_ge_u32 s83, 12
    s_cbranch_scc1 L_lwd_h2
    s_sleep 1
    s_branch L_lw_h2
L_lwd_h2:
    ds_read_b128 v[32:35], v8 offset:0
    ds_read_b128 v[36:39], v8 offset:1024
    ds_read_b128 v[40:43], v8 offset:2048
    ds_read_b128 v[44:47], v8 offset:3072
    ds_read_b128 v[48:51], v8 offset:16384
    ds_read_b128 v[52:55], v8 offset:17408
    ds_read_b128 v[56:59], v8 offset:18432
    ds_read_b128 v[60:63], v8 offset:19456
    ds_read_b128 v[64:67], v8 offset:32768
    ds_read_b128 v[68:71], v8 offset:33792
    ds_read_b128 v[72:75], v8 offset:34816
    ds_read_b128 v[76:79], v8 offset:35840
    ds_read_b128 v[80:83], v8 offset:49152
    ds_read_b128 v[84:87], v8 offset:50176
    ds_read_b128 v[88:91], v8 offset:51200
    ds_read_b128 v[92:95], v8 offset:52224
    buffer_load_dwordx4 v[112:115], v3, s[56:59], s14 offen offset:0
    buffer_load_dwordx4 v[116:119], v3, s[56:59], s14 offen offset:1024
    buffer_load_dwordx4 v[120:123], v3, s[56:59], s14 offen offset:2048
    s_waitcnt lgkmcnt(12)
    v_mul_f32 v96, v12, v32
    v_mul_f32 v97, v12, v33
    v_mul_f32 v98, v12, v34
    v_mul_f32 v99, v12, v35
    v_mul_f32 v100, v12, v36
    v_mul_f32 v101, v12, v37
    v_mul_f32 v102, v12, v38
    v_mul_f32 v103, v12, v39
    v_mul_f32 v104, v12, v40
    v_mul_f32 v105, v12, v41
    v_mul_f32 v106, v12, v42
    v_mul_f32 v107, v12, v43
    v_mul_f32 v108, v12, v44
    v_mul_f32 v109, v12, v45
    v_mul_f32 v110, v12, v46
    v_mul_f32 v111, v12, v47
    s_waitcnt lgkmcnt(8)
    v_fma_f32 v96, v13, v48, v96
    v_fma_f32 v97, v13, v49, v97
    v_fma_f32 v98, v13, v50, v98
    v_fma_f32 v99, v13, v51, v99
    v_fma_f32 v100, v13, v52, v100
    v_fma_f32 v101, v13, v53, v101
    v_fma_f32 v102, v13, v54, v102
    v_fma_f32 v103, v13, v55, v103
    v_fma_f32 v104, v13, v56, v104
    v_fma_f32 v105, v13, v57, v105
    v_fma_f32 v106, v13, v58, v106
    v_fma_f32 v107, v13, v59, v107
    v_fma_f32 v108, v13, v60, v108
    v_fma_f32 v109, v13, v61, v109
    v_fma_f32 v110, v13, v62, v110
    v_fma_f32 v111, v13, v63, v111
    s_waitcnt lgkmcnt(4)
    v_fma_f32 v96, v14, v64, v96
    v_fma_f32 v97, v14, v65, v97
    v_fma_f32 v98, v14, v66, v98
    v_fma_f32 v99, v14, v67, v99
    v_fma_f32 v100, v14, v68, v100
    v_fma_f32 v101, v14, v69, v101
    v_fma_f32 v102, v14, v70, v102
    v_fma_f32 v103, v14, v71, v103
    v_fma_f32 v104, v14, v72, v104
    v_fma_f32 v105, v14, v73, v105
    v_fma_f32 v106, v14, v74, v106
    v_fma_f32 v107, v14, v75, v107
    v_fma_f32 v108, v14, v76, v108
    v_fma_f32 v109, v14, v77, v109
    v_fma_f32 v110, v14, v78, v110
    v_fma_f32 v111, v14, v79, v111
    s_waitcnt lgkmcnt(0)
    s_mov_b64 exec, 1
    ds_add_u32 v24, v10 offset:4
    s_mov_b64 exec, -1
    v_fma_f32 v96, v15, v80, v96
    v_fma_f32 v97, v15, v81, v97
    v_fma_f32 v98, v15, v82, v98
    v_fma_f32 v99, v15, v83, v99
    v_fma_f32 v100, v15, v84, v100
    v_fma_f32 v101, v15, v85, v101
    v_fma_f32 v102, v15, v86, v102
    v_fma_f32 v103, v15, v87, v103
    v_fma_f32 v104, v15, v88, v104
    v_fma_f32 v105, v15, v89, v105
    v_fma_f32 v106, v15, v90, v106
    v_fma_f32 v107, v15, v91, v107
    v_fma_f32 v108, v15, v92, v108
    v_fma_f32 v109, v15, v93, v109
    v_fma_f32 v110, v15, v94, v110
    v_fma_f32 v111, v15, v95, v111
    s_add_u32 s74, s18, 1
    s_and_b32 s74, s74, 0xffff
    s_mov_b32 s82, 1048576
L_poll_m2:
    s_waitcnt vmcnt(0)
    v_xor_b32 v50, s74, v113
    v_xor_b32 v51, s74, v115
    v_or_b32 v50, v50, v51
    v_xor_b32 v51, s74, v117
    v_or_b32 v50, v50, v51
    v_xor_b32 v51, s74, v119
    v_or_b32 v50, v50, v51
    v_xor_b32 v51, s74, v121
    v_or_b32 v50, v50, v51
    v_xor_b32 v51, s74, v123
    v_or_b32 v50, v50, v51
    v_and_b32 v50, 0xffff, v50
    v_cmp_ne_u32 vcc, 0, v50
    s_sub_u32 s82, s82, 1
    s_cmp_eq_u32 s82, 0
    s_cbranch_scc1 L_polldone_m2
    s_cmp_eq_u64 vcc, 0
    s_cbranch_scc1 L_polldone_m2
    s_sleep 2
    buffer_load_dwordx4 v[112:115], v3, s[56:59], s14 offen offset:0 sc1
    buffer_load_dwordx4 v[116:119], v3, s[56:59], s14 offen offset:1024 sc1
    buffer_load_dwordx4 v[120:123], v3, s[56:59], s14 offen offset:2048 sc1
    s_branch L_poll_m2
L_polldone_m2:
    v_lshrrev_b32 v50, 16, v123
    v_and_or_b32 v52, v121, v11, v50
    v_mov_b32 v53, v52
    s_nop 1
    v_permlane32_swap_b32 v52, v53
    s_nop 1
    v_max_f32 v16, v4, v52
    v_sub_f32 v17, v4, v16
    v_sub_f32 v18, v52, v16
    v_mul_f32 v17, s77, v17
    v_mul_f32 v18, s77, v18
    v_exp_f32 v17, v17
    v_exp_f32 v18, v18
    s_nop 0
    v_mul_f32 v17, v17, v5
    v_mul_f32 v18, v18, v53
    v_add_f32 v19, v17, v18
    v_rcp_f32 v21, v19
    v_cndmask_b32 v1, v19, v16, s[22:23]
    v_mul_f32 v17, v17, v21
    v_mul_f32 v18, v18, v21
    v_mul_f32 v96, v17, v96
    v_mul_f32 v97, v17, v97
    v_mul_f32 v98, v17, v98
    v_mul_f32 v99, v17, v99
    v_mul_f32 v100, v17, v100
    v_mul_f32 v101, v17, v101
    v_mul_f32 v102, v17, v102
    v_mul_f32 v103, v17, v103
    v_mul_f32 v104, v17, v104
    v_mul_f32 v105, v17, v105
    v_mul_f32 v106, v17, v106
    v_mul_f32 v107, v17, v107
    v_mul_f32 v108, v17, v108
    v_mul_f32 v109, v17, v109
    v_mul_f32 v110, v17, v110
    v_mul_f32 v111, v17, v111
    v_lshlrev_b32 v27, 16, v112
    v_and_b32 v28, v11, v112
    v_fma_f32 v96, v18, v27, v96
    v_fma_f32 v97, v18, v28, v97
    v_lshlrev_b32 v27, 16, v114
    v_and_b32 v28, v11, v114
    v_fma_f32 v98, v18, v27, v98
    v_fma_f32 v99, v18, v28, v99
    v_lshlrev_b32 v27, 16, v116
    v_and_b32 v28, v11, v116
    v_fma_f32 v100, v18, v27, v100
    v_fma_f32 v101, v18, v28, v101
    v_lshlrev_b32 v27, 16, v118
    v_and_b32 v28, v11, v118
    v_fma_f32 v102, v18, v27, v102
    v_fma_f32 v103, v18, v28, v103
    v_lshlrev_b32 v27, 16, v120
    v_and_b32 v28, v11, v120
    v_fma_f32 v104, v18, v27, v104
    v_fma_f32 v105, v18, v28, v105
    v_lshlrev_b32 v27, 16, v122
    v_and_b32 v28, v11, v122
    v_fma_f32 v106, v18, v27, v106
    v_fma_f32 v107, v18, v28, v107
    v_and_b32 v27, v11, v113
    v_fma_f32 v108, v18, v27, v108
    v_and_b32 v27, v11, v115
    v_fma_f32 v109, v18, v27, v109
    v_and_b32 v27, v11, v117
    v_fma_f32 v110, v18, v27, v110
    v_and_b32 v27, v11, v119
    v_fma_f32 v111, v18, v27, v111
    s_add_u32 s74, s18, 2
    s_and_b32 s74, s74, 0xffff
    v_cvt_pk_bf16_f32 v32, v96, v97
    v_cvt_pk_bf16_f32 v34, v98, v99
    v_cvt_pk_bf16_f32 v36, v100, v101
    v_cvt_pk_bf16_f32 v38, v102, v103
    v_cvt_pk_bf16_f32 v40, v104, v105
    v_cvt_pk_bf16_f32 v42, v106, v107
    v_cvt_pk_bf16_f32 v46, v108, v109
    v_cvt_pk_bf16_f32 v47, v110, v111
    v_lshl_or_b32 v33, v46, 16, s74
    v_and_or_b32 v35, v46, v11, s74
    v_lshl_or_b32 v37, v47, 16, s74
    v_and_or_b32 v39, v47, v11, s74
    v_and_or_b32 v41, v1, v11, s74
    v_lshl_or_b32 v43, v1, 16, s74
    s_cmp_eq_u32 s10, 1
    s_cbranch_scc1 L_pub_f2
    buffer_store_dwordx4 v[32:35], v3, s[56:59], s14 offen offset:0 sc1
    buffer_store_dwordx4 v[36:39], v3, s[56:59], s14 offen offset:1024 sc1
    buffer_store_dwordx4 v[40:43], v3, s[56:59], s14 offen offset:2048 sc1
    s_branch L_pub_e2
L_pub_f2:
    buffer_store_dwordx4 v[32:35], v3, s[56:59], s14 offen offset:0
    buffer_store_dwordx4 v[36:39], v3, s[56:59], s14 offen offset:1024
    buffer_store_dwordx4 v[40:43], v3, s[56:59], s14 offen offset:2048
L_pub_e2:
    s_nop 1
    s_mov_b32 s82, 1048576
L_lw_h3:
    ds_read_b32 v25, v24 offset:0
    s_waitcnt lgkmcnt(0)
    v_readfirstlane_b32 s83, v25
    s_sub_u32 s82, s82, 1
    s_cmp_eq_u32 s82, 0
    s_cbranch_scc1 L_lwd_h3
    s_cmp_ge_u32 s83, 16
    s_cbranch_scc1 L_lwd_h3
    s_sleep 1
    s_branch L_lw_h3
L_lwd_h3:
    ds_read_b128 v[32:35], v8 offset:0
    ds_read_b128 v[36:39], v8 offset:1024
    ds_read_b128 v[40:43], v8 offset:2048
    ds_read_b128 v[44:47], v8 offset:3072
    ds_read_b128 v[48:51], v8 offset:16384
    ds_read_b128 v[52:55], v8 offset:17408
    ds_read_b128 v[56:59], v8 offset:18432
    ds_read_b128 v[60:63], v8 offset:19456
    ds_read_b128 v[64:67], v8 offset:32768
    ds_read_b128 v[68:71], v8 offset:33792
    ds_read_b128 v[72:75], v8 offset:34816
    ds_read_b128 v[76:79], v8 offset:35840
    ds_read_b128 v[80:83], v8 offset:49152
    ds_read_b128 v[84:87], v8 offset:50176
    ds_read_b128 v[88:91], v8 offset:51200
    ds_read_b128 v[92:95], v8 offset:52224
    buffer_load_dwordx4 v[112:115], v3, s[56:59], s15 offen offset:0
    buffer_load_dwordx4 v[116:119], v3, s[56:59], s15 offen offset:1024
    buffer_load_dwordx4 v[120:123], v3, s[56:59], s15 offen offset:2048
    s_waitcnt lgkmcnt(12)
    v_mul_f32 v96, v12, v32
    v_mul_f32 v97, v12, v33
    v_mul_f32 v98, v12, v34
    v_mul_f32 v99, v12, v35
    v_mul_f32 v100, v12, v36
    v_mul_f32 v101, v12, v37
    v_mul_f32 v102, v12, v38
    v_mul_f32 v103, v12, v39
    v_mul_f32 v104, v12, v40
    v_mul_f32 v105, v12, v41
    v_mul_f32 v106, v12, v42
    v_mul_f32 v107, v12, v43
    v_mul_f32 v108, v12, v44
    v_mul_f32 v109, v12, v45
    v_mul_f32 v110, v12, v46
    v_mul_f32 v111, v12, v47
    s_waitcnt lgkmcnt(8)
    v_fma_f32 v96, v13, v48, v96
    v_fma_f32 v97, v13, v49, v97
    v_fma_f32 v98, v13, v50, v98
    v_fma_f32 v99, v13, v51, v99
    v_fma_f32 v100, v13, v52, v100
    v_fma_f32 v101, v13, v53, v101
    v_fma_f32 v102, v13, v54, v102
    v_fma_f32 v103, v13, v55, v103
    v_fma_f32 v104, v13, v56, v104
    v_fma_f32 v105, v13, v57, v105
    v_fma_f32 v106, v13, v58, v106
    v_fma_f32 v107, v13, v59, v107
    v_fma_f32 v108, v13, v60, v108
    v_fma_f32 v109, v13, v61, v109
    v_fma_f32 v110, v13, v62, v110
    v_fma_f32 v111, v13, v63, v111
    s_waitcnt lgkmcnt(4)
    v_fma_f32 v96, v14, v64, v96
    v_fma_f32 v97, v14, v65, v97
    v_fma_f32 v98, v14, v66, v98
    v_fma_f32 v99, v14, v67, v99
    v_fma_f32 v100, v14, v68, v100
    v_fma_f32 v101, v14, v69, v101
    v_fma_f32 v102, v14, v70, v102
    v_fma_f32 v103, v14, v71, v103
    v_fma_f32 v104, v14, v72, v104
    v_fma_f32 v105, v14, v73, v105
    v_fma_f32 v106, v14, v74, v106
    v_fma_f32 v107, v14, v75, v107
    v_fma_f32 v108, v14, v76, v108
    v_fma_f32 v109, v14, v77, v109
    v_fma_f32 v110, v14, v78, v110
    v_fma_f32 v111, v14, v79, v111
    s_waitcnt lgkmcnt(0)
    v_fma_f32 v96, v15, v80, v96
    v_fma_f32 v97, v15, v81, v97
    v_fma_f32 v98, v15, v82, v98
    v_fma_f32 v99, v15, v83, v99
    v_fma_f32 v100, v15, v84, v100
    v_fma_f32 v101, v15, v85, v101
    v_fma_f32 v102, v15, v86, v102
    v_fma_f32 v103, v15, v87, v103
    v_fma_f32 v104, v15, v88, v104
    v_fma_f32 v105, v15, v89, v105
    v_fma_f32 v106, v15, v90, v106
    v_fma_f32 v107, v15, v91, v107
    v_fma_f32 v108, v15, v92, v108
    v_fma_f32 v109, v15, v93, v109
    v_fma_f32 v110, v15, v94, v110
    v_fma_f32 v111, v15, v95, v111
    s_add_u32 s74, s19, 2
    s_and_b32 s74, s74, 0xffff
    s_mov_b32 s82, 1048576
L_poll_m3:
    s_waitcnt vmcnt(0)
    v_xor_b32 v50, s74, v113
    v_xor_b32 v51, s74, v115
    v_or_b32 v50, v50, v51
    v_xor_b32 v51, s74, v117
    v_or_b32 v50, v50, v51
    v_xor_b32 v51, s74, v119
    v_or_b32 v50, v50, v51
    v_xor_b32 v51, s74, v121
    v_or_b32 v50, v50, v51
    v_xor_b32 v51, s74, v123
    v_or_b32 v50, v50, v51
    v_and_b32 v50, 0xffff, v50
    v_cmp_ne_u32 vcc, 0, v50
    s_sub_u32 s82, s82, 1
    s_cmp_eq_u32 s82, 0
    s_cbranch_scc1 L_polldone_m3
    s_cmp_eq_u64 vcc, 0
    s_cbranch_scc1 L_polldone_m3
    s_sleep 2
    buffer_load_dwordx4 v[112:115], v3, s[56:59], s15 offen offset:0 sc1
    buffer_load_dwordx4 v[116:119], v3, s[56:59], s15 offen offset:1024 sc1
    buffer_load_dwordx4 v[120:123], v3, s[56:59], s15 offen offset:2048 sc1
    s_branch L_poll_m3
L_polldone_m3:
    v_lshrrev_b32 v50, 16, v123
    v_and_or_b32 v52, v121, v11, v50
    v_mov_b32 v53, v52
    s_nop 1
    v_permlane32_swap_b32 v52, v53
    s_nop 1
    v_max_f32 v16, v4, v52
    v_sub_f32 v17, v4, v16
    v_sub_f32 v18, v52, v16
    v_mul_f32 v17, s77, v17
    v_mul_f32 v18, s77, v18
    v_exp_f32 v17, v17
    v_exp_f32 v18, v18
    s_nop 0
    v_mul_f32 v17, v17, v5
    v_mul_f32 v18, v18, v53
    v_add_f32 v19, v17, v18
    v_rcp_f32 v21, v19
    v_cndmask_b32 v1, v19, v16, s[22:23]
    v_mul_f32 v17, v17, v21
    v_mul_f32 v18, v18, v21
    v_mul_f32 v96, v17, v96
    v_mul_f32 v97, v17, v97
    v_mul_f32 v98, v17, v98
    v_mul_f32 v99, v17, v99
    v_mul_f32 v100, v17, v100
    v_mul_f32 v101, v17, v101
    v_mul_f32 v102, v17, v102
    v_mul_f32 v103, v17, v103
    v_mul_f32 v104, v17, v104
    v_mul_f32 v105, v17, v105
    v_mul_f32 v106, v17, v106
    v_mul_f32 v107, v17, v107
    v_mul_f32 v108, v17, v108
    v_mul_f32 v109, v17, v109
    v_mul_f32 v110, v17, v110
    v_mul_f32 v111, v17, v111
    v_lshlrev_b32 v27, 16, v112
    v_and_b32 v28, v11, v112
    v_fma_f32 v96, v18, v27, v96
    v_fma_f32 v97, v18, v28, v97
    v_lshlrev_b32 v27, 16, v114
    v_and_b32 v28, v11, v114
    v_fma_f32 v98, v18, v27, v98
    v_fma_f32 v99, v18, v28, v99
    v_lshlrev_b32 v27, 16, v116
    v_and_b32 v28, v11, v116
    v_fma_f32 v100, v18, v27, v100
    v_fma_f32 v101, v18, v28, v101
    v_lshlrev_b32 v27, 16, v118
    v_and_b32 v28, v11, v118
    v_fma_f32 v102, v18, v27, v102
    v_fma_f32 v103, v18, v28, v103
    v_lshlrev_b32 v27, 16, v120
    v_and_b32 v28, v11, v120
    v_fma_f32 v104, v18, v27, v104
    v_fma_f32 v105, v18, v28, v105
    v_lshlrev_b32 v27, 16, v122
    v_and_b32 v28, v11, v122
    v_fma_f32 v106, v18, v27, v106
    v_fma_f32 v107, v18, v28, v107
    v_and_b32 v27, v11, v113
    v_fma_f32 v108, v18, v27, v108
    v_and_b32 v27, v11, v115
    v_fma_f32 v109, v18, v27, v109
    v_and_b32 v27, v11, v117
    v_fma_f32 v110, v18, v27, v110
    v_and_b32 v27, v11, v119
    v_fma_f32 v111, v18, v27, v111
    v_cvt_pk_bf16_f32 v32, v96, v97
    v_cvt_pk_bf16_f32 v33, v98, v99
    v_cvt_pk_bf16_f32 v34, v100, v101
    v_cvt_pk_bf16_f32 v35, v102, v103
    v_cvt_pk_bf16_f32 v36, v104, v105
    v_cvt_pk_bf16_f32 v37, v106, v107
    v_cvt_pk_bf16_f32 v38, v108, v109
    v_cvt_pk_bf16_f32 v39, v110, v111
    s_nop 1
    v_permlane32_swap_b32 v32, v34
    v_permlane32_swap_b32 v33, v35
    v_permlane32_swap_b32 v36, v38
    v_permlane32_swap_b32 v37, v39
    s_nop 1
    buffer_store_dwordx4 v[32:35], v2, s[48:51], s84 offen nt
    buffer_store_dwordx4 v[36:39], v2, s[48:51], s84 offen offset:32 nt
    v_mov_b32 v51, s20
    s_mov_b64 exec, 1
    buffer_store_dword v51, v9, s[56:59], s79 offen sc1
    s_mov_b64 exec, -1
L_end:
    s_endpgm
L_codeend:
.fill 1024, 4, 0xbf800000
.section .rodata,"a"
.p2align 6
.amdhsa_kernel standalone__tree_speculative_verify_tree_attention_over_candidate_token_tree__sampling_kernel
  .amdhsa_next_free_vgpr 256
  .amdhsa_next_free_sgpr 102
  .amdhsa_accum_offset 160
  .amdhsa_group_segment_fixed_size 0
  .amdhsa_kernarg_size 72
  .amdhsa_user_sgpr_count 2
  .amdhsa_user_sgpr_kernarg_segment_ptr 1
  .amdhsa_system_sgpr_workgroup_id_x 1
.end_amdhsa_kernel
```
